```python
import torch

def _softmax(x, axis=-1):
    return torch.softmax(x, dim=axis)
def _gelu(x):
    return torch.nn.functional.gelu(x, approximate="tanh")
def _silu(x):
    return torch.nn.functional.silu(x)
def _sigmoid(x):
    return torch.sigmoid(x)
def _layernorm(x, axis=-1, eps=1e-5):
    m = x.mean(dim=axis, keepdim=True)
    v = x.var(dim=axis, keepdim=True, unbiased=False)
    return (x - m) / torch.sqrt(v + eps)
def _scatter_add(tgt, idx, src, axis=0):
    return tgt.clone().index_add_(axis, idx, src)
def _segment_sum(src, seg, n):
    out = torch.zeros((n,) + src.shape[1:], dtype=src.dtype)
    return out.index_add_(0, seg, src)
def _pad(x, pw):
    flat = tuple(v for pair in reversed(pw) for v in pair)
    return torch.nn.functional.pad(x, flat)

kernel_name = 'concat_heads__sliding_block__softmax_full_mha__prompt'

def setup_inputs():

    _w = (lambda a: (lambda t: t.to(torch.bfloat16) if t.is_floating_point() else t)(torch.as_tensor(a)))
    def _A_setup():
        B, S, D = 1, 2048, 640
        return {
            "x": _w((lambda *s: torch.randn(*s, dtype=torch.bfloat16) * 0.4)(B, S, D)),
            "wqkv": _w((lambda *s: torch.randn(*s, dtype=torch.bfloat16) * 0.4)(D, 3 * D)),
            "wo": _w((lambda *s: torch.randn(*s, dtype=torch.bfloat16) * 0.05)(D, D)),
        }
    _A_in = _A_setup()

    def _B_setup():
        B, S, D = 1, 2048, 640
        return {
            "x": _w((lambda *s: torch.randn(*s, dtype=torch.bfloat16) * 0.2)(B, S, D)),
            "wqkv": _w((lambda *s: torch.randn(*s, dtype=torch.bfloat16) * 0.4)(D, 3 * D)),
            "wo": _w((lambda *s: torch.randn(*s, dtype=torch.bfloat16) * 0.1)(D, D)),
        }
    _B_in = _B_setup()

    return {
        "A_x": _A_in["x"],
        "A_wqkv": _A_in["wqkv"],
        "A_wo": _A_in["wo"],
        "B_x": _B_in["x"],
        "B_wqkv": _B_in["wqkv"],
        "B_wo": _B_in["wo"],
    }

def reference(A_x, A_wqkv, A_wo, B_x, B_wqkv, B_wo):
    def _A_ref(x, wqkv, wo):
        B, S, D = x.shape
        H = 32; Dh = D // H; W = 256
        qkv = (lambda x, *d: x.permute(*d))((x @ wqkv).reshape(B, S, 3, H, Dh), 2, 0, 3, 1, 4)
        q, k, v = qkv[0], qkv[1], qkv[2]
        scores = torch.einsum("bhqd,bhkd->bhqk", q, k) * (Dh ** -0.5)
        idx = torch.arange(S)
        mask = (idx[:, None] - idx[None, :] >= 0) & (idx[:, None] - idx[None, :] < W)
        scores = torch.where(mask[None, None], scores, -1e9)
        p = _softmax(scores, axis=-1)
        o = torch.einsum("bhqk,bhkd->bhqd", p, v)
        return (lambda x, *d: x.permute(*d))(o, 0, 2, 1, 3).reshape(B, S, D) @ wo

    def _B_ref(x, wqkv, wo):
        B, S, D = x.shape
        H = 32; Dh = D // H
        qkv = (lambda x, *d: x.permute(*d))((x @ wqkv).reshape(B, S, 3, H, Dh), 2, 0, 3, 1, 4)
        q, k, v = qkv[0], qkv[1], qkv[2]
        scale = Dh ** -0.5
        scores = torch.einsum("bhqd,bhkd->bhqk", q, k) * scale
        p = _softmax(scores, axis=-1)
        o = torch.einsum("bhqk,bhkd->bhqd", p, v)
        return (lambda x, *d: x.permute(*d))(o, 0, 2, 1, 3).reshape(B, S, D) @ wo

    a = _A_ref(A_x, A_wqkv, A_wo)
    b = _B_ref(B_x, B_wqkv, B_wo)
    return torch.concatenate([a, b], axis=-1)
```

```asm
; @launch grid=(256,1,1) block=(512,1,1) lds=163840
.amdgcn_target "amdgcn-amd-amdhsa--gfx950"
.text
.p2align 8
.globl concat_heads__sliding_block__softmax_full_mha__prompt_kernel
.type concat_heads__sliding_block__softmax_full_mha__prompt_kernel,@function
concat_heads__sliding_block__softmax_full_mha__prompt_kernel:
    s_cmp_ge_u32 s2, 256
    s_cbranch_scc1 concat_heads__sliding_block__softmax_full_mha__prompt_kernel_end
    s_load_dwordx2 s[4:5], s[0:1], 24
    s_load_dwordx2 s[8:9], s[0:1], 32
    s_load_dwordx2 s[28:29], s[0:1], 0
    s_load_dwordx2 s[56:57], s[0:1], 8
    s_load_dwordx2 s[12:13], s[0:1], 64
    s_load_dwordx2 s[60:61], s[0:1], 56
    s_load_dwordx2 s[64:65], s[0:1], 40
    s_load_dwordx2 s[66:67], s[0:1], 16
    s_load_dwordx2 s[68:69], s[0:1], 48
    s_cmp_lt_u32 s2, 240
    s_cbranch_scc1 concat_heads__sliding_block__softmax_full_mha__prompt_kernel_ncp
    s_getpc_b64 s[36:37]
concat_heads__sliding_block__softmax_full_mha__prompt_kernel_pc:
    v_lshlrev_b32 v2, 7, v0
    v_min_u32 v2, concat_heads__sliding_block__softmax_full_mha__prompt_kernel_codeend-concat_heads__sliding_block__softmax_full_mha__prompt_kernel_pc, v2
    v_mov_b32 v3, s37
    v_add_co_u32 v2, vcc, s36, v2
    s_nop 1
    v_addc_co_u32 v3, vcc, 0, v3, vcc
    global_load_dword v31, v[2:3], off
concat_heads__sliding_block__softmax_full_mha__prompt_kernel_ncp:
    v_lshrrev_b32 v2, 6, v0
    v_and_b32 v1, 63, v0
    s_and_b32 s3, s2, 7
    v_readfirstlane_b32 s16, v2
    s_lshr_b32 s32, s2, 3
    s_and_b32 s33, s3, 1
    s_xor_b32 s16, s16, 4
    s_and_b32 s17, s32, 3
    s_lshr_b32 s18, s32, 2
    s_lshl_b32 s35, s33, 3
    s_add_u32 s18, s18, s35
    s_lshl_b32 s35, s33, 1
    s_add_u32 s35, s35, s17
    s_cmp_ge_u32 s32, 28
    s_cselect_b32 s18, 7, s18
    s_cselect_b32 s17, s35, s17
    s_lshr_b32 s34, s3, 1
    s_lshl_b32 s34, s34, 2
    s_add_u32 s17, s17, s34
    s_mov_b32 s6, 2621440
    s_mov_b32 s7, 0x20000
    s_mov_b32 s10, 2457600
    s_mov_b32 s11, 0x20000
    s_mov_b32 s30, 2621440
    s_mov_b32 s31, 0x20000
    s_mov_b32 s58, 2457600
    s_mov_b32 s59, 0x20000
    s_mov_b32 s14, 22642688
    s_mov_b32 s15, 0x20000
    s_mov_b32 s62, 256
    s_mov_b32 s63, 0x20000
    s_mov_b32 s92, 0
    s_mov_b32 s44, 0
    v_lshlrev_b32 v6, 4, v1
    v_lshlrev_b32 v29, 7, v1
    v_mov_b32 v28, 0
    v_lshlrev_b32 v18, 12, v1
    v_min_u32 v18, 8192, v18
    v_mov_b32 v8, 0
    v_mov_b32 v9, 0
    v_mov_b32 v10, 0
    v_mov_b32 v11, 0
    v_mov_b32 v12, 0
    v_mov_b32 v13, 0
    v_mov_b32 v14, 0
    v_mov_b32 v15, 0
    v_mov_b32 v16, 0
    v_mov_b32 v17, 0
    v_mov_b32 v19, 0
    v_mov_b32 v20, 0
    v_mov_b32 v21, 0
    v_mov_b32 v22, 0
    v_mov_b32 v23, 0
    v_mov_b32 v24, 0
    v_mov_b32 v25, 0
    v_mov_b32 v26, 0
    v_mov_b32 v27, 0
    v_mov_b32 v30, 0
    v_mov_b32 v100, 0
    v_mov_b32 v101, 0
    v_mov_b32 v102, 0
    v_mov_b32 v103, 0
    v_mov_b32 v104, 0
    v_mov_b32 v105, 0
    v_mov_b32 v106, 0
    v_mov_b32 v107, 0
    v_mov_b32 v108, 0
    v_mov_b32 v109, 0
    s_cmp_ge_u32 s32, 30
    s_cbranch_scc1 concat_heads__sliding_block__softmax_full_mha__prompt_kernel_idle0
concat_heads__sliding_block__softmax_full_mha__prompt_kernel_main:
    s_cmp_ge_u32 s16, 4
    s_cbranch_scc1 concat_heads__sliding_block__softmax_full_mha__prompt_kernel_setup
    s_setprio 0
    s_lshr_b32 s36, s3, 1
    s_add_u32 s36, s36, s33
    s_and_b32 s36, s36, 1
    s_add_u32 s37, s17, s18
    s_and_b32 s37, s37, 1
    s_lshl_b32 s37, s37, 1
    s_add_u32 s36, s36, s37
    s_mul_i32 s36, s36, 5
    s_add_u32 s36, s36, 1
    s_lshr_b32 s36, s36, 1
    s_lshl_b32 s20, s36, 7
    s_mul_i32 s21, s36, 245760
    s_lshl_b32 s37, s17, 7
    s_lshl_b32 s38, s16, 5
    s_add_u32 s37, s37, s38
    s_mul_i32 s37, s37, 1280
    s_movk_i32 s39, 1280
    s_cmp_ge_u32 s18, 10
    s_cselect_b32 s38, s39, 2560
    s_cselect_b32 s39, 10240, s39
    v_lshrrev_b32 v2, 3, v1
    v_mul_u32_u24 v2, s38, v2
    v_add_u32 v2, s37, v2
    v_and_b32 v3, 7, v1
    v_lshrrev_b32 v4, 4, v1
    v_xor_b32 v3, v3, v4
    v_lshl_add_u32 v100, v3, 4, v2
    v_xor_b32 v3, 4, v3
    v_lshl_add_u32 v101, v3, 4, v2
    v_add_u32 v101, 20480, v101
    v_add_u32 v102, s39, v100
    v_add_u32 v103, s39, v101
    s_mul_i32 s37, s16, 61440
    s_lshl_b32 s38, s18, 8
    s_add_u32 s37, s37, s38
    v_mul_u32_u24 v2, 3840, v4
    v_add_u32 v2, s37, v2
    v_and_b32 v3, 1, v1
    v_lshl_add_u32 v2, v3, 4, v2
    v_bfe_u32 v3, v1, 1, 3
    v_xor_b32 v3, v3, v4
    v_lshl_add_u32 v104, v3, 5, v2
    v_add_u32 v105, 15360, v104
    v_xor_b32 v3, 4, v3
    v_lshl_add_u32 v106, v3, 5, v2
    v_add_u32 v106, 30720, v106
    v_add_u32 v107, 15360, v106
    s_lshl_b32 s40, s16, 12
    s_add_u32 s41, s40, 163840
    s_add_u32 s40, s40, 65536
    s_mov_b32 s22, s40
    s_mov_b32 s44, 0
    s_mov_b32 s45, 1
    s_mov_b32 s47, 5
    s_waitcnt lgkmcnt(0)
    s_cmp_ge_u32 s32, 30
    s_cbranch_scc1 concat_heads__sliding_block__softmax_full_mha__prompt_kernel_setup
L_ld_1:
    s_add_u32 m0, s22, 0
    s_nop 0
    buffer_load_dwordx4 v100, s[4:7], s20 offen lds
    s_add_u32 m0, s22, 16384
    s_nop 0
    buffer_load_dwordx4 v104, s[8:11], s21 offen lds
    s_add_u32 m0, s22, 1024
    s_nop 0
    buffer_load_dwordx4 v101, s[4:7], s20 offen lds
    s_add_u32 m0, s22, 17408
    s_nop 0
    buffer_load_dwordx4 v105, s[8:11], s21 offen lds
    s_add_u32 m0, s22, 2048
    s_nop 0
    buffer_load_dwordx4 v102, s[4:7], s20 offen lds
    s_add_u32 m0, s22, 18432
    s_nop 0
    buffer_load_dwordx4 v106, s[8:11], s21 offen lds
    s_add_u32 m0, s22, 3072
    s_nop 0
    buffer_load_dwordx4 v103, s[4:7], s20 offen lds
    s_add_u32 m0, s22, 19456
    s_nop 0
    buffer_load_dwordx4 v107, s[8:11], s21 offen lds
    s_add_u32 s20, s20, 128
    s_add_u32 s21, s21, 245760
    s_cmp_eq_u32 s20, 1280
    s_cselect_b32 s20, 0, s20
    s_cselect_b32 s21, 0, s21
    s_add_u32 s22, s22, 32768
    s_cmp_eq_u32 s22, s41
    s_cselect_b32 s22, s40, s22
    s_add_u32 s44, s44, 1
    s_cmp_eq_u32 s44, 10
    s_cselect_b64 s[4:5], s[28:29], s[4:5]
    s_cselect_b64 s[8:9], s[56:57], s[8:9]
    s_cselect_b32 s20, 0, s20
    s_cselect_b32 s21, 0, s21
    s_cmp_eq_u32 s44, s45
    s_cbranch_scc1 L_later_2
L_sync_4:
    s_waitcnt vmcnt(8)
L_bar_5:
    s_barrier
    s_cmp_lg_u32 s44, s47
    s_cbranch_scc1 L_ld_1
    s_cmp_eq_u32 s44, 19
    s_cbranch_scc1 L_zq_6
    s_mov_b32 s47, 19
    s_mov_b64 exec, 0xfffff
    buffer_load_dword v15, v29, s[28:31], s48 offen
    s_mov_b64 exec, 0x7ffff
    buffer_load_dword v16, v29, s[56:59], s49 offen
    s_mov_b64 exec, -1
    s_mov_b64 exec, 1
    buffer_load_dword v17, v28, s[60:63], 0 offen sc1
    s_mov_b64 exec, -1
    s_branch concat_heads__sliding_block__softmax_full_mha__prompt_kernel_setup
L_zq_6:
    buffer_load_dword v17, v18, s[12:15], s54 offen sc1
    s_branch L_ld_1
L_later_2:
    s_cmp_eq_u32 s44, 20
    s_cbranch_scc1 L_ltail_8
    s_setprio 0
    s_cmp_eq_u32 s44, 13
    s_cbranch_scc1 concat_heads__sliding_block__softmax_full_mha__prompt_kernel_setup2
    s_cmp_lt_u32 s44, 3
    s_cbranch_scc1 L_first_9
    s_mov_b32 s45, 13
    s_waitcnt vmcnt(11)
    s_branch L_bar_5
concat_heads__sliding_block__softmax_full_mha__prompt_kernel_tret:
    s_waitcnt vmcnt(3)
    s_barrier
    s_branch L_ld_1
L_first_9:
    s_mov_b32 s45, 2
    s_cmp_eq_u32 s44, 1
    s_cbranch_scc1 L_ld_1
    s_mov_b32 s45, 6
    s_lshl_b32 s37, s2, 2
    s_add_u32 s37, s37, s16
    s_mul_i32 s48, s37, 2560
    s_mul_i32 s49, s37, 2432
    s_branch L_sync_4
concat_heads__sliding_block__softmax_full_mha__prompt_kernel_lret:
    s_add_u32 s54, s97, 12288
    s_mov_b32 s55, s96
    s_add_u32 s52, s75, s76
    s_sub_u32 s52, s52, 57344
    s_lshl_b32 s53, s70, 6
    s_add_u32 s53, s53, s73
    s_mul_i32 s53, s53, 1280
    s_add_u32 s53, s53, 13107200
    s_mov_b32 s45, 20
    s_cmp_ge_u32 s32, 30
    s_cbranch_scc1 concat_heads__sliding_block__softmax_full_mha__prompt_kernel_idle
L_zc_7:
    v_readfirstlane_b32 s46, v17
    s_cmp_eq_u32 s46, 1
    s_cbranch_scc1 L_sync_4
    s_add_u32 s92, s92, 1
    s_cmp_gt_u32 s92, 2000000
    s_cbranch_scc1 L_sync_4
    buffer_load_dword v17, v28, s[60:63], 0 offen sc1
    s_waitcnt vmcnt(0)
    s_branch L_zc_7
L_ltail_8:
    s_waitcnt vmcnt(8)
    v_cmp_ne_u32 vcc, s55, v17
    s_mov_b32 s45, 1
    s_barrier
    s_cbranch_vccz L_go_12
    buffer_load_dword v17, v18, s[12:15], s54 offen sc1
    s_mov_b32 s45, 0
    s_waitcnt vmcnt(1)
    s_barrier
concat_heads__sliding_block__softmax_full_mha__prompt_kernel_lpoll:
    s_waitcnt vmcnt(0)
    v_cmp_ne_u32 vcc, s55, v17
    s_cbranch_vccz L_go_12
    s_add_u32 s92, s92, 1
    s_cmp_gt_u32 s92, 2000000
    s_cbranch_scc1 L_go_12
    s_sleep 1
    buffer_load_dword v17, v18, s[12:15], s54 offen sc1
    s_branch concat_heads__sliding_block__softmax_full_mha__prompt_kernel_lpoll
L_go_12:
    s_lshl_b32 m0, s16, 11
    s_lshl_b32 s47, s16, 11
    s_sub_u32 s47, s52, s47
    buffer_load_dwordx2 v[144:145], v8, s[12:15], s53 offen offset:0 sc1
    buffer_load_dwordx2 v[146:147], v8, s[12:15], s53 offen offset:512 sc1
    buffer_load_dwordx2 v[148:149], v8, s[12:15], s53 offen offset:1280 sc1
    buffer_load_dwordx2 v[150:151], v8, s[12:15], s53 offen offset:1792 sc1
    buffer_load_dwordx2 v[156:157], v8, s[12:15], s47 offen offset:0 sc1
    buffer_load_dwordx2 v[158:159], v8, s[12:15], s47 offen offset:512 sc1
    s_mov_b64 exec, s[26:27]
    buffer_load_dwordx2 v[32:33], v8, s[12:15], s53 offen offset:1024 sc1
    buffer_load_dwordx2 v[34:35], v8, s[12:15], s53 offen offset:2304 sc1
    buffer_load_dwordx2 v[38:39], v8, s[12:15], s47 offen offset:1024 sc1
    s_mov_b64 exec, -1
    buffer_load_dwordx4 v6, s[12:15], s52 offen sc1 lds
    buffer_load_dwordx4 v6, s[12:15], s52 offen offset:1024 sc1 lds
    s_add_u32 m0, m0, 8192
    s_add_u32 s52, s52, 8192
    buffer_load_dwordx4 v6, s[12:15], s52 offen sc1 lds
    buffer_load_dwordx4 v6, s[12:15], s52 offen offset:1024 sc1 lds
    s_add_u32 m0, m0, 8192
    s_add_u32 s52, s52, 8192
    buffer_load_dwordx4 v6, s[12:15], s52 offen sc1 lds
    buffer_load_dwordx4 v6, s[12:15], s52 offen offset:1024 sc1 lds
    s_add_u32 m0, m0, 8192
    s_add_u32 s52, s52, 8192
    s_cmp_eq_u32 s45, 0
    s_cbranch_scc1 L_sec_13
    s_waitcnt vmcnt(15)
    s_barrier
L_sec_13:
    buffer_load_dwordx4 v6, s[12:15], s52 offen sc1 lds
    buffer_load_dwordx4 v6, s[12:15], s52 offen offset:1024 sc1 lds
    s_add_u32 m0, m0, 8192
    s_add_u32 s52, s52, 8192
    buffer_load_dwordx4 v6, s[12:15], s52 offen sc1 lds
    buffer_load_dwordx4 v6, s[12:15], s52 offen offset:1024 sc1 lds
    s_add_u32 m0, m0, 8192
    s_add_u32 s52, s52, 8192
    buffer_load_dwordx4 v6, s[12:15], s52 offen sc1 lds
    buffer_load_dwordx4 v6, s[12:15], s52 offen offset:1024 sc1 lds
    s_add_u32 m0, m0, 8192
    s_add_u32 s52, s52, 8192
    buffer_load_dwordx4 v6, s[12:15], s52 offen sc1 lds
    buffer_load_dwordx4 v6, s[12:15], s52 offen offset:1024 sc1 lds
    s_add_u32 m0, m0, 8192
    s_add_u32 s52, s52, 8192
    s_setprio 3
    s_waitcnt vmcnt(14)
    v_mfma_f32_32x32x8_bf16 v[112:127], v[38:39], v[32:33], 0
    v_mfma_f32_32x32x16_bf16 v[112:127], v[156:159], v[144:147], v[112:127]
    v_mfma_f32_32x32x8_bf16 v[128:143], v[38:39], v[34:35], 0
    v_mfma_f32_32x32x16_bf16 v[128:143], v[156:159], v[148:151], v[128:143]
    v_mov_b32 v106, 1073741824
    v_mov_b32 v107, 1073741824
    v_mov_b32 v108, 1073741824
    v_mov_b32 v109, 1073741824
    s_mov_b64 vcc, 0
    s_nop 4
    v_max3_f32 v15, v112, v113, v114
    v_max3_f32 v15, v15, v115, v116
    v_max3_f32 v15, v15, v117, v118
    v_max3_f32 v15, v15, v119, v120
    v_max3_f32 v15, v15, v121, v122
    v_max3_f32 v15, v15, v123, v124
    v_max3_f32 v15, v15, v125, v126
    v_max_f32 v15, v15, v127
    v_mov_b32 v5, v15
    s_nop 1
    v_permlane32_swap_b32 v5, v15
    s_nop 1
    v_max_f32 v15, v15, v5
    v_sub_f32 v2, 0, v15
    v_and_b32 v3, s23, v2
    v_sub_f32 v2, v2, v3
    v_and_b32 v4, s23, v2
    v_sub_f32 v2, v2, v4
    v_lshrrev_b32 v3, 16, v3
    s_mov_b64 exec, s[100:101]
    v_or_b32 v32, v3, v4
    v_lshrrev_b32 v33, 16, v2
    s_mov_b64 exec, -1
    s_nop 0
    v_mfma_f32_32x32x8_bf16 v[112:127], v[38:39], v[32:33], 0
    v_mfma_f32_32x32x16_bf16 v[112:127], v[156:159], v[144:147], v[112:127]
    v_max3_f32 v15, v128, v129, v130
    v_max3_f32 v15, v15, v131, v132
    v_max3_f32 v15, v15, v133, v134
    v_max3_f32 v15, v15, v135, v136
    v_max3_f32 v15, v15, v137, v138
    v_max3_f32 v15, v15, v139, v140
    v_max3_f32 v15, v15, v141, v142
    v_max_f32 v15, v15, v143
    v_mov_b32 v5, v15
    s_nop 1
    v_permlane32_swap_b32 v5, v15
    s_nop 1
    v_max_f32 v15, v15, v5
    v_sub_f32 v2, 0, v15
    v_and_b32 v3, s23, v2
    v_sub_f32 v2, v2, v3
    v_and_b32 v4, s23, v2
    v_sub_f32 v2, v2, v4
    v_lshrrev_b32 v3, 16, v3
    s_mov_b64 exec, s[100:101]
    v_or_b32 v34, v3, v4
    v_lshrrev_b32 v35, 16, v2
    s_mov_b64 exec, -1
    ds_write_b128 v26, v[144:147] offset:0
    ds_write_b64 v27, v[32:33] offset:1024
    ds_write_b128 v26, v[148:151] offset:1536
    ds_write_b64 v27, v[34:35] offset:2560
    s_waitcnt vmcnt(0) lgkmcnt(0)
    s_barrier
    s_mov_b64 exec, s[24:25]
    ds_read_b128 v[44:47], v12 offset:0
    ds_read_b128 v[48:51], v12 offset:640
    s_mov_b64 exec, -1
    ds_read2st64_b64 v[160:163], v11 offset0:10 offset1:11
    s_mov_b64 exec, s[26:27]
    ds_read_b64 v[40:41], v11 offset:6144
    s_mov_b64 exec, -1
    s_branch concat_heads__sliding_block__softmax_full_mha__prompt_kernel_bpro
concat_heads__sliding_block__softmax_full_mha__prompt_kernel_setup:
    s_mul_hi_u32 s35, s18, 858993460
    s_mul_i32 s36, s35, 5
    s_sub_u32 s36, s18, s36
    s_lshl_b32 s36, s36, 7
    s_mul_hi_u32 s37, s36, 214748365
    s_add_u32 s36, s36, 127
    s_mul_hi_u32 s36, s36, 214748365
    s_sub_u32 s36, s36, s37
    s_add_u32 s36, s36, 1
    s_bfm_b64 s[94:95], s36, 0
    s_lshl_b32 s35, s35, 5
    s_add_u32 s35, s35, s37
    s_lshl_b32 s93, s35, 7
    s_add_u32 s93, s93, 20971520
    s_lshl_b32 s70, s3, 2
    s_and_b32 s35, s32, 3
    s_add_u32 s70, s70, s35
    s_lshr_b32 s71, s32, 2
    s_lshr_b32 s72, s16, 2
    s_and_b32 s35, s16, 3
    s_lshl_b32 s35, s35, 1
    s_add_u32 s35, s35, s72
    s_lshl_b32 s74, s71, 3
    s_add_u32 s73, s74, s35
    s_sub_u32 s38, s74, 8
    s_max_i32 s38, s38, 0
    s_add_u32 s74, s74, s16
    s_sub_u32 s79, s74, s38
    s_sub_u32 s79, s79, 9
    s_mul_i32 s79, s79, 2560
    s_lshl_b32 s76, s16, 10
    s_lshl_b32 s39, s70, 6
    s_add_u32 s78, s39, s38
    s_mul_i32 s78, s78, 2560
    s_add_u32 s78, s78, s76
    s_add_u32 s77, s39, s74
    s_mul_i32 s77, s77, 1280
    s_add_u32 s77, s77, 10485760
    s_add_u32 s39, s39, 2048
    s_mul_i32 s75, s39, 2560
    s_add_u32 s75, s75, s76
    s_add_u32 s75, s75, 57344
    v_cmp_gt_u32 vcc, 32, v1
    v_lshlrev_b32 v8, 3, v1
    v_add_u32 v4, 1024, v8
    v_mov_b32 v3, 1073741824
    v_cndmask_b32 v9, v3, v4, vcc
    v_cmp_eq_u32 vcc, 256, v0
    s_and_b32 s36, s16, 3
    s_mul_i32 s36, s36, 3072
    s_add_u32 s36, s36, 131072
    v_add_u32 v26, s36, v6
    v_add_u32 v27, s36, v8
    v_cndmask_b32 v25, v3, 0, vcc
    s_mov_b32 s24, 0x000fffff
    s_mov_b32 s25, 0x000fffff
    s_mov_b32 s26, -1
    s_mov_b32 s27, 0
    s_mov_b32 s100, 0
    s_mov_b32 s101, -1
    s_mov_b32 s19, 0xff800000
    s_mov_b32 s23, 0xffff0000
    v_and_b32 v2, 31, v1
    v_lshrrev_b32 v3, 5, v1
    v_mul_u32_u24 v10, 320, v3
    v_lshl_add_u32 v10, v2, 4, v10
    v_add_u32 v10, 1280, v10
    s_mul_i32 s35, s72, 2560
    v_add_u32 v11, s35, v8
    v_add_u32 v12, s35, v10
    v_bfe_u32 v4, v1, 4, 1
    v_mul_u32_u24 v4, 20480, v4
    v_and_b32 v5, 15, v1
    v_lshl_add_u32 v14, v5, 3, v4
    v_lshl_add_u32 v13, v3, 8, v4
    v_lshl_add_u32 v13, v5, 4, v13
    s_lshl_b32 s35, s70, 9
    s_lshr_b32 s36, s70, 3
    s_lshl_b32 s36, s36, 10
    s_and_b32 s37, s70, 3
    s_lshl_b32 s37, s37, 8
    s_add_u32 s36, s36, s37
    s_bfe_u32 s37, s70, 0x10002
    s_lshl_b32 s37, s37, 7
    s_add_u32 s36, s36, s37
    s_add_u32 s36, s36, 16384
    s_mul_i32 s37, s73, 40960
    s_add_u32 s37, s37, 18350080
    s_add_u32 s80, s37, s35
    s_add_u32 s81, s37, s36
    s_mul_i32 s37, s74, 40960
    s_add_u32 s37, s37, 15728640
    s_add_u32 s82, s37, s35
    s_add_u32 s83, s37, s36
    s_cmp_eq_u32 s44, 5
    s_cbranch_scc1 L_ld_1
concat_heads__sliding_block__softmax_full_mha__prompt_kernel_setup2:
    s_lshl_b32 s84, s71, 7
    s_add_u32 s84, s84, 20996096
    s_lshl_b32 s85, s3, 7
    s_add_u32 s85, s85, 20996096
    s_mul_i32 s36, s70, 20
    s_add_u32 s37, s36, 19
    s_lshr_b32 s36, s36, 7
    s_lshr_b32 s37, s37, 7
    s_sub_u32 s36, s37, s36
    s_add_u32 s36, s36, 1
    s_lshl_b32 s96, s36, 4
    s_lshl_b32 s97, s70, 7
    s_add_u32 s97, s97, 20971520
    s_mul_i32 s37, s71, 160
    s_mul_i32 s36, s72, 15360
    s_add_u32 s36, s36, 20480
    v_add_u32 v20, s36, v6
    s_mul_i32 s36, s72, 35840
    s_add_u32 s36, s36, 51200
    v_add_u32 v21, s36, v6
    v_lshrrev_b32 v4, 4, v1
    v_lshlrev_b32 v30, 8, v4
    v_lshl_add_u32 v30, v5, 3, v30
    v_mul_u32_u24 v24, 40, v4
    v_mul_u32_u24 v4, 2560, v5
    v_add_u32 v24, v24, v4
    v_cmp_gt_u32 vcc, 3, v1
    s_lshl_b32 s36, s71, 7
    s_add_u32 s36, s36, 20998144
    s_sub_u32 s36, s36, s97
    v_mov_b32 v2, s36
    v_mov_b32 v4, s96
    v_cndmask_b32 v22, v2, v18, vcc
    v_cndmask_b32 v23, 2, v4, vcc
    s_mul_i32 s33, s71, 102400
    s_add_u32 s33, s33, 21004288
    s_add_u32 s33, s33, s76
    s_lshl_b32 s98, s70, 2
    s_and_b32 s36, s16, 3
    s_add_u32 s98, s98, s36
    s_mul_i32 s99, s98, 40960
    s_add_u32 s99, s99, s37
    s_mul_i32 s98, s98, 20480
    s_add_u32 s98, s98, 15728640
    v_pk_mov_b32 v[44:45], 0, 0
    v_pk_mov_b32 v[46:47], 0, 0
    v_pk_mov_b32 v[48:49], 0, 0
    v_pk_mov_b32 v[50:51], 0, 0
    v_mov_b32 v38, 1065369472
    v_mov_b32 v39, 1065369472
    v_pk_mov_b32 v[68:69], 0, 0
    v_pk_mov_b32 v[70:71], 0, 0
    v_pk_mov_b32 v[72:73], 0, 0
    v_pk_mov_b32 v[74:75], 0, 0
    v_pk_mov_b32 v[76:77], 0, 0
    v_pk_mov_b32 v[78:79], 0, 0
    v_pk_mov_b32 v[80:81], 0, 0
    v_pk_mov_b32 v[82:83], 0, 0
    v_pk_mov_b32 v[32:33], 0, 0
    v_pk_mov_b32 v[52:53], 0, 0
    v_pk_mov_b32 v[54:55], 0, 0
    v_pk_mov_b32 v[56:57], 0, 0
    v_pk_mov_b32 v[58:59], 0, 0
    v_mov_b32 v40, 1065369472
    v_mov_b32 v41, 1065369472
    v_pk_mov_b32 v[84:85], 0, 0
    v_pk_mov_b32 v[86:87], 0, 0
    v_pk_mov_b32 v[88:89], 0, 0
    v_pk_mov_b32 v[90:91], 0, 0
    v_pk_mov_b32 v[92:93], 0, 0
    v_pk_mov_b32 v[94:95], 0, 0
    v_pk_mov_b32 v[96:97], 0, 0
    v_pk_mov_b32 v[98:99], 0, 0
    v_pk_mov_b32 v[34:35], 0, 0
    v_pk_mov_b32 v[60:61], 0, 0
    v_pk_mov_b32 v[62:63], 0, 0
    v_pk_mov_b32 v[64:65], 0, 0
    v_pk_mov_b32 v[66:67], 0, 0
    s_mov_b32 exec_lo, 0x11000000
    s_mov_b32 exec_hi, 0x11000000
    v_pk_mov_b32 v[44:45], v[38:39], v[38:39] op_sel:[0,1]
    v_pk_mov_b32 v[46:47], v[38:39], v[38:39] op_sel:[0,1]
    v_pk_mov_b32 v[48:49], v[38:39], v[38:39] op_sel:[0,1]
    v_pk_mov_b32 v[50:51], v[38:39], v[38:39] op_sel:[0,1]
    v_pk_mov_b32 v[52:53], v[38:39], v[38:39] op_sel:[0,1]
    v_pk_mov_b32 v[54:55], v[38:39], v[38:39] op_sel:[0,1]
    v_pk_mov_b32 v[56:57], v[38:39], v[38:39] op_sel:[0,1]
    v_pk_mov_b32 v[58:59], v[38:39], v[38:39] op_sel:[0,1]
    s_mov_b64 exec, -1
    s_waitcnt lgkmcnt(0)
    s_cmp_lt_u32 s16, 4
    s_cbranch_scc1 concat_heads__sliding_block__softmax_full_mha__prompt_kernel_lret
    s_cmp_ge_u32 s32, 30
    s_cbranch_scc1 concat_heads__sliding_block__softmax_full_mha__prompt_kernel_sbar
    s_and_b32 s37, s16, 1
    s_bfe_u32 s38, s16, 0x10001
    s_lshl_b32 s39, s37, 13
    s_add_u32 s39, s39, 65536
    v_and_b32 v2, 15, v1
    v_lshrrev_b32 v4, 4, v1
    v_lshlrev_b32 v3, 7, v2
    v_add_u32 v3, s39, v3
    v_bfe_u32 v5, v1, 1, 3
    v_xor_b32 v5, v5, v4
    v_lshl_add_u32 v100, v5, 4, v3
    v_xor_b32 v5, 4, v5
    v_lshl_add_u32 v101, v5, 4, v3
    v_bfe_u32 v3, v1, 2, 2
    v_lshl_add_u32 v3, v4, 3, v3
    v_lshlrev_b32 v3, 8, v3
    v_and_b32 v5, 3, v1
    v_lshl_add_u32 v3, v5, 3, v3
    v_add_u32 v3, 81920, v3
    v_bfe_u32 v5, v1, 2, 3
    s_lshl_b32 s39, s38, 2
    v_xor_b32 v5, s39, v5
    v_xor_b32 v106, 0, v5
    v_lshl_add_u32 v102, v106, 5, v3
    v_xor_b32 v106, 1, v5
    v_lshl_add_u32 v103, v106, 5, v3
    v_xor_b32 v106, 2, v5
    v_lshl_add_u32 v104, v106, 5, v3
    v_xor_b32 v106, 3, v5
    v_lshl_add_u32 v105, v106, 5, v3
    s_lshl_b32 s41, s17, 2
    s_lshl_b32 s37, s37, 1
    s_add_u32 s41, s41, s37
    s_add_u32 s41, s41, 2048
    s_movk_i32 s50, 1280
    s_cmp_ge_u32 s18, 5
    s_cselect_b32 s48, 1.0, 1051011932
    s_cselect_b32 s50, 2560, s50
    s_cselect_b32 s51, 0, 10485760
    s_cselect_b32 s43, 5, 0
    s_mov_b32 s49, s48
    s_mul_i32 s41, s41, s50
    s_add_u32 s51, s51, s41
    s_lshl_b32 s52, s50, 11
    s_mov_b32 s22, 65536
    s_mov_b32 s44, 0
    s_mov_b32 s47, 10
    s_mov_b32 s41, 10
    v_pk_mov_b32 v[176:177], 0, 0
    v_pk_mov_b32 v[178:179], 0, 0
    v_pk_mov_b32 v[180:181], 0, 0
    v_pk_mov_b32 v[182:183], 0, 0
    v_pk_mov_b32 v[184:185], 0, 0
    v_pk_mov_b32 v[186:187], 0, 0
    v_pk_mov_b32 v[188:189], 0, 0
    v_pk_mov_b32 v[190:191], 0, 0
    v_pk_mov_b32 v[192:193], 0, 0
    v_pk_mov_b32 v[194:195], 0, 0
    v_pk_mov_b32 v[196:197], 0, 0
    v_pk_mov_b32 v[198:199], 0, 0
    v_pk_mov_b32 v[200:201], 0, 0
    v_pk_mov_b32 v[202:203], 0, 0
    v_pk_mov_b32 v[204:205], 0, 0
    v_pk_mov_b32 v[206:207], 0, 0
    v_pk_mov_b32 v[208:209], 0, 0
    v_pk_mov_b32 v[210:211], 0, 0
    v_pk_mov_b32 v[212:213], 0, 0
    v_pk_mov_b32 v[214:215], 0, 0
    v_pk_mov_b32 v[216:217], 0, 0
    v_pk_mov_b32 v[218:219], 0, 0
    v_pk_mov_b32 v[220:221], 0, 0
    v_pk_mov_b32 v[222:223], 0, 0
    v_pk_mov_b32 v[224:225], 0, 0
    v_pk_mov_b32 v[226:227], 0, 0
    v_pk_mov_b32 v[228:229], 0, 0
    v_pk_mov_b32 v[230:231], 0, 0
    v_pk_mov_b32 v[232:233], 0, 0
    v_pk_mov_b32 v[234:235], 0, 0
    v_pk_mov_b32 v[236:237], 0, 0
    v_pk_mov_b32 v[238:239], 0, 0
    s_cmp_ge_u32 s18, 10
    s_cbranch_scc1 concat_heads__sliding_block__softmax_full_mha__prompt_kernel_vt
    s_sub_u32 s43, s18, s43
    s_lshl_b32 s43, s43, 5
    s_lshl_b32 s39, s38, 4
    s_add_u32 s43, s43, s39
    s_mov_b32 s54, 858993460
    s_lshl_b32 s42, s50, 6
    s_sub_u32 s42, s42, 1280
    v_add_u32 v3, s43, v4
    v_add_u32 v3, 0, v3
    v_mul_hi_u32 v5, s54, v3
    v_lshlrev_b32 v3, 8, v3
    v_mad_u32_u24 v3, v5, s42, v3
    v_lshl_add_u32 v106, v2, 4, v3
    v_add_u32 v3, s43, v4
    v_add_u32 v3, 4, v3
    v_mul_hi_u32 v5, s54, v3
    v_lshlrev_b32 v3, 8, v3
    v_mad_u32_u24 v3, v5, s42, v3
    v_lshl_add_u32 v107, v2, 4, v3
    v_add_u32 v3, s43, v4
    v_add_u32 v3, 8, v3
    v_mul_hi_u32 v5, s54, v3
    v_lshlrev_b32 v3, 8, v3
    v_mad_u32_u24 v3, v5, s42, v3
    v_lshl_add_u32 v108, v2, 4, v3
    v_add_u32 v3, s43, v4
    v_add_u32 v3, 12, v3
    v_mul_hi_u32 v5, s54, v3
    v_lshlrev_b32 v3, 8, v3
    v_mad_u32_u24 v3, v5, s42, v3
    v_lshl_add_u32 v109, v2, 4, v3
    s_setprio 2
    s_add_u32 s53, s51, s50
    s_barrier
    ds_read_b64_tr_b16 v[144:145], v102 offset:0
    ds_read_b64_tr_b16 v[146:147], v102 offset:1024
    ds_read_b128 v[112:115], v100 offset:0
    ds_read_b64_tr_b16 v[148:149], v103 offset:0
    ds_read_b64_tr_b16 v[150:151], v103 offset:1024
    ds_read_b128 v[116:119], v100 offset:2048
    ds_read_b64_tr_b16 v[152:153], v104 offset:0
    ds_read_b64_tr_b16 v[154:155], v104 offset:1024
    ds_read_b128 v[120:123], v100 offset:4096
    ds_read_b64_tr_b16 v[156:157], v105 offset:0
    ds_read_b64_tr_b16 v[158:159], v105 offset:1024
    ds_read_b128 v[124:127], v100 offset:6144
.p2align 6
L_gloop_14:
    s_waitcnt lgkmcnt(0)
    v_mfma_f32_16x16x32_bf16 v[176:179], v[144:147], v[112:115], v[176:179]
    ds_read_b64_tr_b16 v[160:161], v102 offset:8192
    ds_read_b64_tr_b16 v[162:163], v102 offset:9216
    v_mfma_f32_16x16x32_bf16 v[192:195], v[148:151], v[112:115], v[192:195]
    ds_read_b128 v[128:131], v101 offset:0
    v_mfma_f32_16x16x32_bf16 v[208:211], v[152:155], v[112:115], v[208:211]
    ds_read_b64_tr_b16 v[164:165], v103 offset:8192
    ds_read_b64_tr_b16 v[166:167], v103 offset:9216
    v_mfma_f32_16x16x32_bf16 v[224:227], v[156:159], v[112:115], v[224:227]
    ds_read_b128 v[132:135], v101 offset:2048
    v_mfma_f32_16x16x32_bf16 v[180:183], v[144:147], v[116:119], v[180:183]
    ds_read_b64_tr_b16 v[168:169], v104 offset:8192
    ds_read_b64_tr_b16 v[170:171], v104 offset:9216
    v_mfma_f32_16x16x32_bf16 v[196:199], v[148:151], v[116:119], v[196:199]
    ds_read_b128 v[136:139], v101 offset:4096
    v_mfma_f32_16x16x32_bf16 v[212:215], v[152:155], v[116:119], v[212:215]
    ds_read_b64_tr_b16 v[172:173], v105 offset:8192
    ds_read_b64_tr_b16 v[174:175], v105 offset:9216
    v_mfma_f32_16x16x32_bf16 v[228:231], v[156:159], v[116:119], v[228:231]
    ds_read_b128 v[140:143], v101 offset:6144
    v_mfma_f32_16x16x32_bf16 v[184:187], v[144:147], v[120:123], v[184:187]
    s_add_u32 s45, s22, 32768
    s_cmp_eq_u32 s45, 163840
    v_mfma_f32_16x16x32_bf16 v[200:203], v[148:151], v[120:123], v[200:203]
    s_cselect_b32 s45, 65536, s45
    s_sub_u32 s46, s45, s22
    v_mfma_f32_16x16x32_bf16 v[216:219], v[152:155], v[120:123], v[216:219]
    v_add_u32 v100, s46, v100
    v_mfma_f32_16x16x32_bf16 v[232:235], v[156:159], v[120:123], v[232:235]
    v_add_u32 v101, s46, v101
    v_add_u32 v102, s46, v102
    v_mfma_f32_16x16x32_bf16 v[188:191], v[144:147], v[124:127], v[188:191]
    v_add_u32 v103, s46, v103
    v_mfma_f32_16x16x32_bf16 v[204:207], v[148:151], v[124:127], v[204:207]
    v_add_u32 v104, s46, v104
    v_add_u32 v105, s46, v105
    v_mfma_f32_16x16x32_bf16 v[220:223], v[152:155], v[124:127], v[220:223]
    s_cmp_eq_u32 s44, s41
    v_mfma_f32_16x16x32_bf16 v[236:239], v[156:159], v[124:127], v[236:239]
    s_waitcnt lgkmcnt(0)
    s_cbranch_scc1 L_csp_16
    s_barrier
L_nb_15:
    v_mfma_f32_16x16x32_bf16 v[176:179], v[160:163], v[128:131], v[176:179]
    ds_read_b64_tr_b16 v[144:145], v102 offset:0
    ds_read_b64_tr_b16 v[146:147], v102 offset:1024
    v_mfma_f32_16x16x32_bf16 v[192:195], v[164:167], v[128:131], v[192:195]
    ds_read_b128 v[112:115], v100 offset:0
    v_mfma_f32_16x16x32_bf16 v[208:211], v[168:171], v[128:131], v[208:211]
    ds_read_b64_tr_b16 v[148:149], v103 offset:0
    ds_read_b64_tr_b16 v[150:151], v103 offset:1024
    v_mfma_f32_16x16x32_bf16 v[224:227], v[172:175], v[128:131], v[224:227]
    ds_read_b128 v[116:119], v100 offset:2048
    v_mfma_f32_16x16x32_bf16 v[180:183], v[160:163], v[132:135], v[180:183]
    ds_read_b64_tr_b16 v[152:153], v104 offset:0
    ds_read_b64_tr_b16 v[154:155], v104 offset:1024
    v_mfma_f32_16x16x32_bf16 v[196:199], v[164:167], v[132:135], v[196:199]
    ds_read_b128 v[120:123], v100 offset:4096
    v_mfma_f32_16x16x32_bf16 v[212:215], v[168:171], v[132:135], v[212:215]
    ds_read_b64_tr_b16 v[156:157], v105 offset:0
    ds_read_b64_tr_b16 v[158:159], v105 offset:1024
    v_mfma_f32_16x16x32_bf16 v[228:231], v[172:175], v[132:135], v[228:231]
    ds_read_b128 v[124:127], v100 offset:6144
    v_mfma_f32_16x16x32_bf16 v[184:187], v[160:163], v[136:139], v[184:187]
    s_mov_b32 s22, s45
    v_mfma_f32_16x16x32_bf16 v[200:203], v[164:167], v[136:139], v[200:203]
    s_add_u32 s44, s44, 1
    v_mfma_f32_16x16x32_bf16 v[216:219], v[168:171], v[136:139], v[216:219]
    s_cmp_lt_u32 s44, s47
    v_mfma_f32_16x16x32_bf16 v[232:235], v[172:175], v[136:139], v[232:235]
    v_mfma_f32_16x16x32_bf16 v[188:191], v[160:163], v[140:143], v[188:191]
    v_mfma_f32_16x16x32_bf16 v[204:207], v[164:167], v[140:143], v[204:207]
    v_mfma_f32_16x16x32_bf16 v[220:223], v[168:171], v[140:143], v[220:223]
    v_mfma_f32_16x16x32_bf16 v[236:239], v[172:175], v[140:143], v[236:239]
    s_cbranch_scc1 L_gloop_14
    s_cmp_eq_u32 s44, 20
    s_cbranch_scc1 L_fin_17
    s_nop 4
    v_pk_mul_f32 v[176:177], v[176:177], s[48:49]
    v_pk_mul_f32 v[178:179], v[178:179], s[48:49]
    v_pk_mul_f32 v[180:181], v[180:181], s[48:49]
    v_pk_mul_f32 v[182:183], v[182:183], s[48:49]
    v_cvt_pk_bf16_f32 v68, v176, v177
    v_cvt_pk_bf16_f32 v69, v178, v179
    v_cvt_pk_bf16_f32 v70, v180, v181
    v_cvt_pk_bf16_f32 v71, v182, v183
    v_pk_mul_f32 v[192:193], v[192:193], s[48:49]
    v_pk_mul_f32 v[194:195], v[194:195], s[48:49]
    v_pk_mul_f32 v[196:197], v[196:197], s[48:49]
    v_pk_mul_f32 v[198:199], v[198:199], s[48:49]
    v_cvt_pk_bf16_f32 v72, v192, v193
    v_cvt_pk_bf16_f32 v73, v194, v195
    v_cvt_pk_bf16_f32 v74, v196, v197
    v_cvt_pk_bf16_f32 v75, v198, v199
    v_pk_mul_f32 v[208:209], v[208:209], s[48:49]
    v_pk_mul_f32 v[210:211], v[210:211], s[48:49]
    v_pk_mul_f32 v[212:213], v[212:213], s[48:49]
    v_pk_mul_f32 v[214:215], v[214:215], s[48:49]
    v_cvt_pk_bf16_f32 v76, v208, v209
    v_cvt_pk_bf16_f32 v77, v210, v211
    v_cvt_pk_bf16_f32 v78, v212, v213
    v_cvt_pk_bf16_f32 v79, v214, v215
    v_pk_mul_f32 v[224:225], v[224:225], s[48:49]
    v_pk_mul_f32 v[226:227], v[226:227], s[48:49]
    v_pk_mul_f32 v[228:229], v[228:229], s[48:49]
    v_pk_mul_f32 v[230:231], v[230:231], s[48:49]
    v_cvt_pk_bf16_f32 v80, v224, v225
    v_cvt_pk_bf16_f32 v81, v226, v227
    v_cvt_pk_bf16_f32 v82, v228, v229
    v_cvt_pk_bf16_f32 v83, v230, v231
    v_pk_mul_f32 v[184:185], v[184:185], s[48:49]
    v_pk_mul_f32 v[186:187], v[186:187], s[48:49]
    v_pk_mul_f32 v[188:189], v[188:189], s[48:49]
    v_pk_mul_f32 v[190:191], v[190:191], s[48:49]
    v_cvt_pk_bf16_f32 v84, v184, v185
    v_cvt_pk_bf16_f32 v85, v186, v187
    v_cvt_pk_bf16_f32 v86, v188, v189
    v_cvt_pk_bf16_f32 v87, v190, v191
    v_pk_mul_f32 v[200:201], v[200:201], s[48:49]
    v_pk_mul_f32 v[202:203], v[202:203], s[48:49]
    v_pk_mul_f32 v[204:205], v[204:205], s[48:49]
    v_pk_mul_f32 v[206:207], v[206:207], s[48:49]
    v_cvt_pk_bf16_f32 v88, v200, v201
    v_cvt_pk_bf16_f32 v89, v202, v203
    v_cvt_pk_bf16_f32 v90, v204, v205
    v_cvt_pk_bf16_f32 v91, v206, v207
    v_pk_mul_f32 v[216:217], v[216:217], s[48:49]
    v_pk_mul_f32 v[218:219], v[218:219], s[48:49]
    v_pk_mul_f32 v[220:221], v[220:221], s[48:49]
    v_pk_mul_f32 v[222:223], v[222:223], s[48:49]
    v_cvt_pk_bf16_f32 v92, v216, v217
    v_cvt_pk_bf16_f32 v93, v218, v219
    v_cvt_pk_bf16_f32 v94, v220, v221
    v_cvt_pk_bf16_f32 v95, v222, v223
    v_pk_mul_f32 v[232:233], v[232:233], s[48:49]
    v_pk_mul_f32 v[234:235], v[234:235], s[48:49]
    v_pk_mul_f32 v[236:237], v[236:237], s[48:49]
    v_pk_mul_f32 v[238:239], v[238:239], s[48:49]
    v_cvt_pk_bf16_f32 v96, v232, v233
    v_cvt_pk_bf16_f32 v97, v234, v235
    v_cvt_pk_bf16_f32 v98, v236, v237
    v_cvt_pk_bf16_f32 v99, v238, v239
    v_pk_mov_b32 v[176:177], 0, 0
    v_pk_mov_b32 v[178:179], 0, 0
    v_pk_mov_b32 v[180:181], 0, 0
    v_pk_mov_b32 v[182:183], 0, 0
    v_pk_mov_b32 v[184:185], 0, 0
    v_pk_mov_b32 v[186:187], 0, 0
    v_pk_mov_b32 v[188:189], 0, 0
    v_pk_mov_b32 v[190:191], 0, 0
    v_pk_mov_b32 v[192:193], 0, 0
    v_pk_mov_b32 v[194:195], 0, 0
    v_pk_mov_b32 v[196:197], 0, 0
    v_pk_mov_b32 v[198:199], 0, 0
    v_pk_mov_b32 v[200:201], 0, 0
    v_pk_mov_b32 v[202:203], 0, 0
    v_pk_mov_b32 v[204:205], 0, 0
    v_pk_mov_b32 v[206:207], 0, 0
    v_pk_mov_b32 v[208:209], 0, 0
    v_pk_mov_b32 v[210:211], 0, 0
    v_pk_mov_b32 v[212:213], 0, 0
    v_pk_mov_b32 v[214:215], 0, 0
    v_pk_mov_b32 v[216:217], 0, 0
    v_pk_mov_b32 v[218:219], 0, 0
    v_pk_mov_b32 v[220:221], 0, 0
    v_pk_mov_b32 v[222:223], 0, 0
    v_pk_mov_b32 v[224:225], 0, 0
    v_pk_mov_b32 v[226:227], 0, 0
    v_pk_mov_b32 v[228:229], 0, 0
    v_pk_mov_b32 v[230:231], 0, 0
    v_pk_mov_b32 v[232:233], 0, 0
    v_pk_mov_b32 v[234:235], 0, 0
    v_pk_mov_b32 v[236:237], 0, 0
    v_pk_mov_b32 v[238:239], 0, 0
    s_mov_b32 s47, 20
    s_branch L_gloop_14
L_csp_16:
    s_cmp_eq_u32 s44, 10
    s_cbranch_scc1 L_hk_18
    s_cmp_eq_u32 s44, 11
    s_cbranch_scc1 L_hk_19
    s_cmp_eq_u32 s44, 19
    s_cbranch_scc1 L_nb_15
    s_mov_b32 s41, 19
    s_sub_u32 s51, s51, s52
    s_sub_u32 s53, s53, s52
    v_mov_b32 v3, 1
    s_add_u32 s42, s93, 12288
    s_waitcnt vmcnt(0)
    s_barrier
    s_cmp_lg_u32 s16, 4
    s_cbranch_scc1 L_nb_15
    s_mov_b64 exec, s[94:95]
    buffer_atomic_add v3, v29, s[12:15], s42 offen sc1
    s_mov_b64 exec, 1
    s_cmp_eq_u32 s2, 0
    s_cselect_b32 s42, 128, 1073741824
    buffer_store_dword v3, v28, s[60:63], s42 offen sc1
    s_mov_b64 exec, -1
    s_branch L_nb_15
L_hk_18:
    buffer_store_dwordx4 v[68:71], v106, s[12:15], s51 offen sc1
    buffer_store_dwordx4 v[72:75], v107, s[12:15], s51 offen sc1
    buffer_store_dwordx4 v[76:79], v108, s[12:15], s51 offen sc1
    buffer_store_dwordx4 v[80:83], v109, s[12:15], s51 offen sc1
    s_mov_b32 s41, 11
    s_barrier
    s_branch L_nb_15
L_hk_19:
    buffer_store_dwordx4 v[84:87], v106, s[12:15], s53 offen sc1
    buffer_store_dwordx4 v[88:91], v107, s[12:15], s53 offen sc1
    buffer_store_dwordx4 v[92:95], v108, s[12:15], s53 offen sc1
    buffer_store_dwordx4 v[96:99], v109, s[12:15], s53 offen sc1
    s_mov_b32 s41, 12
    s_barrier
    s_branch L_nb_15
L_fin_17:
    s_waitcnt lgkmcnt(0)
    s_barrier
    s_setprio 3
    ds_read_b128 v[144:147], v26 offset:1536
    ds_read_b64 v[32:33], v27 offset:2560
    ds_read_b128 v[148:151], v26 offset:0
    ds_read_b64 v[34:35], v27 offset:1024
    ds_read2st64_b64 v[156:159], v11 offset0:0 offset1:1
    s_mov_b64 exec, s[26:27]
    ds_read_b64 v[38:39], v11 offset:1024
    s_mov_b64 exec, s[24:25]
    ds_read_b128 v[44:47], v12 offset:0
    ds_read_b128 v[48:51], v12 offset:640
    s_mov_b64 exec, -1
    ds_read2st64_b64 v[160:163], v11 offset0:10 offset1:11
    s_mov_b64 exec, s[26:27]
    ds_read_b64 v[40:41], v11 offset:6144
    s_mov_b64 exec, -1
    v_pk_mov_b32 v[68:69], 0, 0
    v_pk_mov_b32 v[70:71], 0, 0
    v_pk_mov_b32 v[72:73], 0, 0
    v_pk_mov_b32 v[74:75], 0, 0
    v_pk_mov_b32 v[76:77], 0, 0
    v_pk_mov_b32 v[78:79], 0, 0
    v_pk_mov_b32 v[80:81], 0, 0
    v_pk_mov_b32 v[82:83], 0, 0
    v_pk_mov_b32 v[84:85], 0, 0
    v_pk_mov_b32 v[86:87], 0, 0
    v_pk_mov_b32 v[88:89], 0, 0
    v_pk_mov_b32 v[90:91], 0, 0
    v_pk_mov_b32 v[92:93], 0, 0
    v_pk_mov_b32 v[94:95], 0, 0
    v_pk_mov_b32 v[96:97], 0, 0
    v_pk_mov_b32 v[98:99], 0, 0
    v_pk_mul_f32 v[176:177], v[176:177], s[48:49]
    v_pk_mul_f32 v[178:179], v[178:179], s[48:49]
    v_pk_mul_f32 v[180:181], v[180:181], s[48:49]
    v_pk_mul_f32 v[182:183], v[182:183], s[48:49]
    v_cvt_pk_bf16_f32 v176, v176, v177
    v_cvt_pk_bf16_f32 v177, v178, v179
    v_cvt_pk_bf16_f32 v178, v180, v181
    v_cvt_pk_bf16_f32 v179, v182, v183
    v_pk_mul_f32 v[192:193], v[192:193], s[48:49]
    v_pk_mul_f32 v[194:195], v[194:195], s[48:49]
    v_pk_mul_f32 v[196:197], v[196:197], s[48:49]
    v_pk_mul_f32 v[198:199], v[198:199], s[48:49]
    v_cvt_pk_bf16_f32 v192, v192, v193
    v_cvt_pk_bf16_f32 v193, v194, v195
    v_cvt_pk_bf16_f32 v194, v196, v197
    v_cvt_pk_bf16_f32 v195, v198, v199
    v_pk_mul_f32 v[208:209], v[208:209], s[48:49]
    v_pk_mul_f32 v[210:211], v[210:211], s[48:49]
    v_pk_mul_f32 v[212:213], v[212:213], s[48:49]
    v_pk_mul_f32 v[214:215], v[214:215], s[48:49]
    v_cvt_pk_bf16_f32 v208, v208, v209
    v_cvt_pk_bf16_f32 v209, v210, v211
    v_cvt_pk_bf16_f32 v210, v212, v213
    v_cvt_pk_bf16_f32 v211, v214, v215
    v_pk_mul_f32 v[224:225], v[224:225], s[48:49]
    v_pk_mul_f32 v[226:227], v[226:227], s[48:49]
    v_pk_mul_f32 v[228:229], v[228:229], s[48:49]
    v_pk_mul_f32 v[230:231], v[230:231], s[48:49]
    v_cvt_pk_bf16_f32 v224, v224, v225
    v_cvt_pk_bf16_f32 v225, v226, v227
    v_cvt_pk_bf16_f32 v226, v228, v229
    v_cvt_pk_bf16_f32 v227, v230, v231
    v_pk_mul_f32 v[184:185], v[184:185], s[48:49]
    v_pk_mul_f32 v[186:187], v[186:187], s[48:49]
    v_pk_mul_f32 v[188:189], v[188:189], s[48:49]
    v_pk_mul_f32 v[190:191], v[190:191], s[48:49]
    v_cvt_pk_bf16_f32 v184, v184, v185
    v_cvt_pk_bf16_f32 v185, v186, v187
    v_cvt_pk_bf16_f32 v186, v188, v189
    v_cvt_pk_bf16_f32 v187, v190, v191
    v_pk_mul_f32 v[200:201], v[200:201], s[48:49]
    v_pk_mul_f32 v[202:203], v[202:203], s[48:49]
    v_pk_mul_f32 v[204:205], v[204:205], s[48:49]
    v_pk_mul_f32 v[206:207], v[206:207], s[48:49]
    v_cvt_pk_bf16_f32 v200, v200, v201
    v_cvt_pk_bf16_f32 v201, v202, v203
    v_cvt_pk_bf16_f32 v202, v204, v205
    v_cvt_pk_bf16_f32 v203, v206, v207
    v_pk_mul_f32 v[216:217], v[216:217], s[48:49]
    v_pk_mul_f32 v[218:219], v[218:219], s[48:49]
    v_pk_mul_f32 v[220:221], v[220:221], s[48:49]
    v_pk_mul_f32 v[222:223], v[222:223], s[48:49]
    v_cvt_pk_bf16_f32 v216, v216, v217
    v_cvt_pk_bf16_f32 v217, v218, v219
    v_cvt_pk_bf16_f32 v218, v220, v221
    v_cvt_pk_bf16_f32 v219, v222, v223
    v_pk_mul_f32 v[232:233], v[232:233], s[48:49]
    v_pk_mul_f32 v[234:235], v[234:235], s[48:49]
    v_pk_mul_f32 v[236:237], v[236:237], s[48:49]
    v_pk_mul_f32 v[238:239], v[238:239], s[48:49]
    v_cvt_pk_bf16_f32 v232, v232, v233
    v_cvt_pk_bf16_f32 v233, v234, v235
    v_cvt_pk_bf16_f32 v234, v236, v237
    v_cvt_pk_bf16_f32 v235, v238, v239
    s_mov_b64 vcc, -1
    s_branch concat_heads__sliding_block__softmax_full_mha__prompt_kernel_cjoin
concat_heads__sliding_block__softmax_full_mha__prompt_kernel_vt:
    s_sub_u32 s43, s18, 10
    s_lshl_b32 s43, s43, 7
    s_lshl_b32 s39, s38, 6
    s_add_u32 s43, s43, s39
    s_mov_b32 s54, 214748365
    s_mov_b32 s42, 163520
    v_mul_u32_u24 v4, 320, v4
    v_add_u32 v4, 1280, v4
    v_add_u32 v3, s43, v2
    v_add_u32 v3, 0, v3
    v_mul_hi_u32 v5, s54, v3
    v_lshl_add_u32 v3, v3, 4, v4
    v_mad_u32_u24 v106, v5, s42, v3
    v_add_u32 v3, s43, v2
    v_add_u32 v3, 16, v3
    v_mul_hi_u32 v5, s54, v3
    v_lshl_add_u32 v3, v3, 4, v4
    v_mad_u32_u24 v107, v5, s42, v3
    v_add_u32 v3, s43, v2
    v_add_u32 v3, 32, v3
    v_mul_hi_u32 v5, s54, v3
    v_lshl_add_u32 v3, v3, 4, v4
    v_mad_u32_u24 v108, v5, s42, v3
    v_add_u32 v3, s43, v2
    v_add_u32 v3, 48, v3
    v_mul_hi_u32 v5, s54, v3
    v_lshl_add_u32 v3, v3, 4, v4
    v_mad_u32_u24 v109, v5, s42, v3
    s_setprio 2
    s_add_u32 s53, s51, s50
    s_barrier
    ds_read_b64_tr_b16 v[144:145], v102 offset:0
    ds_read_b64_tr_b16 v[146:147], v102 offset:1024
    ds_read_b128 v[112:115], v100 offset:0
    ds_read_b64_tr_b16 v[148:149], v103 offset:0
    ds_read_b64_tr_b16 v[150:151], v103 offset:1024
    ds_read_b128 v[116:119], v100 offset:2048
    ds_read_b64_tr_b16 v[152:153], v104 offset:0
    ds_read_b64_tr_b16 v[154:155], v104 offset:1024
    ds_read_b128 v[120:123], v100 offset:4096
    ds_read_b64_tr_b16 v[156:157], v105 offset:0
    ds_read_b64_tr_b16 v[158:159], v105 offset:1024
    ds_read_b128 v[124:127], v100 offset:6144
.p2align 6
L_gloop_20:
    s_waitcnt lgkmcnt(0)
    v_mfma_f32_16x16x32_bf16 v[176:179], v[112:115], v[144:147], v[176:179]
    ds_read_b64_tr_b16 v[160:161], v102 offset:8192
    ds_read_b64_tr_b16 v[162:163], v102 offset:9216
    v_mfma_f32_16x16x32_bf16 v[192:195], v[112:115], v[148:151], v[192:195]
    ds_read_b128 v[128:131], v101 offset:0
    v_mfma_f32_16x16x32_bf16 v[208:211], v[112:115], v[152:155], v[208:211]
    ds_read_b64_tr_b16 v[164:165], v103 offset:8192
    ds_read_b64_tr_b16 v[166:167], v103 offset:9216
    v_mfma_f32_16x16x32_bf16 v[224:227], v[112:115], v[156:159], v[224:227]
    ds_read_b128 v[132:135], v101 offset:2048
    v_mfma_f32_16x16x32_bf16 v[180:183], v[116:119], v[144:147], v[180:183]
    ds_read_b64_tr_b16 v[168:169], v104 offset:8192
    ds_read_b64_tr_b16 v[170:171], v104 offset:9216
    v_mfma_f32_16x16x32_bf16 v[196:199], v[116:119], v[148:151], v[196:199]
    ds_read_b128 v[136:139], v101 offset:4096
    v_mfma_f32_16x16x32_bf16 v[212:215], v[116:119], v[152:155], v[212:215]
    ds_read_b64_tr_b16 v[172:173], v105 offset:8192
    ds_read_b64_tr_b16 v[174:175], v105 offset:9216
    v_mfma_f32_16x16x32_bf16 v[228:231], v[116:119], v[156:159], v[228:231]
    ds_read_b128 v[140:143], v101 offset:6144
    v_mfma_f32_16x16x32_bf16 v[184:187], v[120:123], v[144:147], v[184:187]
    s_add_u32 s45, s22, 32768
    s_cmp_eq_u32 s45, 163840
    v_mfma_f32_16x16x32_bf16 v[200:203], v[120:123], v[148:151], v[200:203]
    s_cselect_b32 s45, 65536, s45
    s_sub_u32 s46, s45, s22
    v_mfma_f32_16x16x32_bf16 v[216:219], v[120:123], v[152:155], v[216:219]
    v_add_u32 v100, s46, v100
    v_mfma_f32_16x16x32_bf16 v[232:235], v[120:123], v[156:159], v[232:235]
    v_add_u32 v101, s46, v101
    v_add_u32 v102, s46, v102
    v_mfma_f32_16x16x32_bf16 v[188:191], v[124:127], v[144:147], v[188:191]
    v_add_u32 v103, s46, v103
    v_mfma_f32_16x16x32_bf16 v[204:207], v[124:127], v[148:151], v[204:207]
    v_add_u32 v104, s46, v104
    v_add_u32 v105, s46, v105
    v_mfma_f32_16x16x32_bf16 v[220:223], v[124:127], v[152:155], v[220:223]
    s_cmp_eq_u32 s44, s41
    v_mfma_f32_16x16x32_bf16 v[236:239], v[124:127], v[156:159], v[236:239]
    s_waitcnt lgkmcnt(0)
    s_cbranch_scc1 L_csp_22
    s_barrier
L_nb_21:
    v_mfma_f32_16x16x32_bf16 v[176:179], v[128:131], v[160:163], v[176:179]
    ds_read_b64_tr_b16 v[144:145], v102 offset:0
    ds_read_b64_tr_b16 v[146:147], v102 offset:1024
    v_mfma_f32_16x16x32_bf16 v[192:195], v[128:131], v[164:167], v[192:195]
    ds_read_b128 v[112:115], v100 offset:0
    v_mfma_f32_16x16x32_bf16 v[208:211], v[128:131], v[168:171], v[208:211]
    ds_read_b64_tr_b16 v[148:149], v103 offset:0
    ds_read_b64_tr_b16 v[150:151], v103 offset:1024
    v_mfma_f32_16x16x32_bf16 v[224:227], v[128:131], v[172:175], v[224:227]
    ds_read_b128 v[116:119], v100 offset:2048
    v_mfma_f32_16x16x32_bf16 v[180:183], v[132:135], v[160:163], v[180:183]
    ds_read_b64_tr_b16 v[152:153], v104 offset:0
    ds_read_b64_tr_b16 v[154:155], v104 offset:1024
    v_mfma_f32_16x16x32_bf16 v[196:199], v[132:135], v[164:167], v[196:199]
    ds_read_b128 v[120:123], v100 offset:4096
    v_mfma_f32_16x16x32_bf16 v[212:215], v[132:135], v[168:171], v[212:215]
    ds_read_b64_tr_b16 v[156:157], v105 offset:0
    ds_read_b64_tr_b16 v[158:159], v105 offset:1024
    v_mfma_f32_16x16x32_bf16 v[228:231], v[132:135], v[172:175], v[228:231]
    ds_read_b128 v[124:127], v100 offset:6144
    v_mfma_f32_16x16x32_bf16 v[184:187], v[136:139], v[160:163], v[184:187]
    s_mov_b32 s22, s45
    v_mfma_f32_16x16x32_bf16 v[200:203], v[136:139], v[164:167], v[200:203]
    s_add_u32 s44, s44, 1
    v_mfma_f32_16x16x32_bf16 v[216:219], v[136:139], v[168:171], v[216:219]
    s_cmp_lt_u32 s44, s47
    v_mfma_f32_16x16x32_bf16 v[232:235], v[136:139], v[172:175], v[232:235]
    v_mfma_f32_16x16x32_bf16 v[188:191], v[140:143], v[160:163], v[188:191]
    v_mfma_f32_16x16x32_bf16 v[204:207], v[140:143], v[164:167], v[204:207]
    v_mfma_f32_16x16x32_bf16 v[220:223], v[140:143], v[168:171], v[220:223]
    v_mfma_f32_16x16x32_bf16 v[236:239], v[140:143], v[172:175], v[236:239]
    s_cbranch_scc1 L_gloop_20
    s_cmp_eq_u32 s44, 20
    s_cbranch_scc1 L_fin_23
    s_nop 4
    v_cvt_pk_bf16_f32 v68, v176, v177
    v_cvt_pk_bf16_f32 v69, v178, v179
    v_cvt_pk_bf16_f32 v70, v180, v181
    v_cvt_pk_bf16_f32 v71, v182, v183
    v_cvt_pk_bf16_f32 v72, v192, v193
    v_cvt_pk_bf16_f32 v73, v194, v195
    v_cvt_pk_bf16_f32 v74, v196, v197
    v_cvt_pk_bf16_f32 v75, v198, v199
    v_cvt_pk_bf16_f32 v76, v208, v209
    v_cvt_pk_bf16_f32 v77, v210, v211
    v_cvt_pk_bf16_f32 v78, v212, v213
    v_cvt_pk_bf16_f32 v79, v214, v215
    v_cvt_pk_bf16_f32 v80, v224, v225
    v_cvt_pk_bf16_f32 v81, v226, v227
    v_cvt_pk_bf16_f32 v82, v228, v229
    v_cvt_pk_bf16_f32 v83, v230, v231
    v_cvt_pk_bf16_f32 v84, v184, v185
    v_cvt_pk_bf16_f32 v85, v186, v187
    v_cvt_pk_bf16_f32 v86, v188, v189
    v_cvt_pk_bf16_f32 v87, v190, v191
    v_cvt_pk_bf16_f32 v88, v200, v201
    v_cvt_pk_bf16_f32 v89, v202, v203
    v_cvt_pk_bf16_f32 v90, v204, v205
    v_cvt_pk_bf16_f32 v91, v206, v207
    v_cvt_pk_bf16_f32 v92, v216, v217
    v_cvt_pk_bf16_f32 v93, v218, v219
    v_cvt_pk_bf16_f32 v94, v220, v221
    v_cvt_pk_bf16_f32 v95, v222, v223
    v_cvt_pk_bf16_f32 v96, v232, v233
    v_cvt_pk_bf16_f32 v97, v234, v235
    v_cvt_pk_bf16_f32 v98, v236, v237
    v_cvt_pk_bf16_f32 v99, v238, v239
    v_pk_mov_b32 v[176:177], 0, 0
    v_pk_mov_b32 v[178:179], 0, 0
    v_pk_mov_b32 v[180:181], 0, 0
    v_pk_mov_b32 v[182:183], 0, 0
    v_pk_mov_b32 v[184:185], 0, 0
    v_pk_mov_b32 v[186:187], 0, 0
    v_pk_mov_b32 v[188:189], 0, 0
    v_pk_mov_b32 v[190:191], 0, 0
    v_pk_mov_b32 v[192:193], 0, 0
    v_pk_mov_b32 v[194:195], 0, 0
    v_pk_mov_b32 v[196:197], 0, 0
    v_pk_mov_b32 v[198:199], 0, 0
    v_pk_mov_b32 v[200:201], 0, 0
    v_pk_mov_b32 v[202:203], 0, 0
    v_pk_mov_b32 v[204:205], 0, 0
    v_pk_mov_b32 v[206:207], 0, 0
    v_pk_mov_b32 v[208:209], 0, 0
    v_pk_mov_b32 v[210:211], 0, 0
    v_pk_mov_b32 v[212:213], 0, 0
    v_pk_mov_b32 v[214:215], 0, 0
    v_pk_mov_b32 v[216:217], 0, 0
    v_pk_mov_b32 v[218:219], 0, 0
    v_pk_mov_b32 v[220:221], 0, 0
    v_pk_mov_b32 v[222:223], 0, 0
    v_pk_mov_b32 v[224:225], 0, 0
    v_pk_mov_b32 v[226:227], 0, 0
    v_pk_mov_b32 v[228:229], 0, 0
    v_pk_mov_b32 v[230:231], 0, 0
    v_pk_mov_b32 v[232:233], 0, 0
    v_pk_mov_b32 v[234:235], 0, 0
    v_pk_mov_b32 v[236:237], 0, 0
    v_pk_mov_b32 v[238:239], 0, 0
    s_mov_b32 s47, 20
    s_branch L_gloop_20
L_csp_22:
    s_cmp_eq_u32 s44, 10
    s_cbranch_scc1 L_hk_24
    s_cmp_eq_u32 s44, 11
    s_cbranch_scc1 L_hk_25
    s_cmp_eq_u32 s44, 19
    s_cbranch_scc1 L_nb_21
    s_mov_b32 s41, 19
    s_sub_u32 s51, s51, s52
    s_sub_u32 s53, s53, s52
    v_mov_b32 v3, 1
    s_add_u32 s42, s93, 12288
    s_waitcnt vmcnt(0)
    s_barrier
    s_cmp_lg_u32 s16, 4
    s_cbranch_scc1 L_nb_21
    s_mov_b64 exec, s[94:95]
    buffer_atomic_add v3, v29, s[12:15], s42 offen sc1
    s_mov_b64 exec, 1
    s_cmp_eq_u32 s2, 0
    s_cselect_b32 s42, 128, 1073741824
    buffer_store_dword v3, v28, s[60:63], s42 offen sc1
    s_mov_b64 exec, -1
    s_branch L_nb_21
L_hk_24:
    buffer_store_dwordx4 v[68:71], v106, s[12:15], s51 offen sc1
    buffer_store_dwordx4 v[72:75], v107, s[12:15], s51 offen sc1
    buffer_store_dwordx4 v[76:79], v108, s[12:15], s51 offen sc1
    buffer_store_dwordx4 v[80:83], v109, s[12:15], s51 offen sc1
    s_mov_b32 s41, 11
    s_barrier
    s_branch L_nb_21
L_hk_25:
    buffer_store_dwordx4 v[84:87], v106, s[12:15], s53 offen sc1
    buffer_store_dwordx4 v[88:91], v107, s[12:15], s53 offen sc1
    buffer_store_dwordx4 v[92:95], v108, s[12:15], s53 offen sc1
    buffer_store_dwordx4 v[96:99], v109, s[12:15], s53 offen sc1
    s_mov_b32 s41, 12
    s_barrier
    s_branch L_nb_21
L_fin_23:
    s_waitcnt lgkmcnt(0)
    s_barrier
    s_setprio 3
    ds_read_b128 v[144:147], v26 offset:1536
    ds_read_b64 v[32:33], v27 offset:2560
    ds_read_b128 v[148:151], v26 offset:0
    ds_read_b64 v[34:35], v27 offset:1024
    ds_read2st64_b64 v[156:159], v11 offset0:0 offset1:1
    s_mov_b64 exec, s[26:27]
    ds_read_b64 v[38:39], v11 offset:1024
    s_mov_b64 exec, s[24:25]
    ds_read_b128 v[44:47], v12 offset:0
    ds_read_b128 v[48:51], v12 offset:640
    s_mov_b64 exec, -1
    ds_read2st64_b64 v[160:163], v11 offset0:10 offset1:11
    s_mov_b64 exec, s[26:27]
    ds_read_b64 v[40:41], v11 offset:6144
    s_mov_b64 exec, -1
    v_pk_mov_b32 v[68:69], 0, 0
    v_pk_mov_b32 v[70:71], 0, 0
    v_pk_mov_b32 v[72:73], 0, 0
    v_pk_mov_b32 v[74:75], 0, 0
    v_pk_mov_b32 v[76:77], 0, 0
    v_pk_mov_b32 v[78:79], 0, 0
    v_pk_mov_b32 v[80:81], 0, 0
    v_pk_mov_b32 v[82:83], 0, 0
    v_pk_mov_b32 v[84:85], 0, 0
    v_pk_mov_b32 v[86:87], 0, 0
    v_pk_mov_b32 v[88:89], 0, 0
    v_pk_mov_b32 v[90:91], 0, 0
    v_pk_mov_b32 v[92:93], 0, 0
    v_pk_mov_b32 v[94:95], 0, 0
    v_pk_mov_b32 v[96:97], 0, 0
    v_pk_mov_b32 v[98:99], 0, 0
    v_cvt_pk_bf16_f32 v176, v176, v177
    v_cvt_pk_bf16_f32 v177, v178, v179
    v_cvt_pk_bf16_f32 v178, v180, v181
    v_cvt_pk_bf16_f32 v179, v182, v183
    v_cvt_pk_bf16_f32 v192, v192, v193
    v_cvt_pk_bf16_f32 v193, v194, v195
    v_cvt_pk_bf16_f32 v194, v196, v197
    v_cvt_pk_bf16_f32 v195, v198, v199
    v_cvt_pk_bf16_f32 v208, v208, v209
    v_cvt_pk_bf16_f32 v209, v210, v211
    v_cvt_pk_bf16_f32 v210, v212, v213
    v_cvt_pk_bf16_f32 v211, v214, v215
    v_cvt_pk_bf16_f32 v224, v224, v225
    v_cvt_pk_bf16_f32 v225, v226, v227
    v_cvt_pk_bf16_f32 v226, v228, v229
    v_cvt_pk_bf16_f32 v227, v230, v231
    v_cvt_pk_bf16_f32 v184, v184, v185
    v_cvt_pk_bf16_f32 v185, v186, v187
    v_cvt_pk_bf16_f32 v186, v188, v189
    v_cvt_pk_bf16_f32 v187, v190, v191
    v_cvt_pk_bf16_f32 v200, v200, v201
    v_cvt_pk_bf16_f32 v201, v202, v203
    v_cvt_pk_bf16_f32 v202, v204, v205
    v_cvt_pk_bf16_f32 v203, v206, v207
    v_cvt_pk_bf16_f32 v216, v216, v217
    v_cvt_pk_bf16_f32 v217, v218, v219
    v_cvt_pk_bf16_f32 v218, v220, v221
    v_cvt_pk_bf16_f32 v219, v222, v223
    v_cvt_pk_bf16_f32 v232, v232, v233
    v_cvt_pk_bf16_f32 v233, v234, v235
    v_cvt_pk_bf16_f32 v234, v236, v237
    v_cvt_pk_bf16_f32 v235, v238, v239
    s_mov_b64 vcc, -1
    s_branch concat_heads__sliding_block__softmax_full_mha__prompt_kernel_cjoin
concat_heads__sliding_block__softmax_full_mha__prompt_kernel_sbar:
    v_mov_b32 v106, 1073741824
    v_mov_b32 v107, 1073741824
    v_mov_b32 v108, 1073741824
    v_mov_b32 v109, 1073741824
    s_mov_b64 vcc, 0
    s_waitcnt vmcnt(0)
    s_barrier
    ds_read_b128 v[144:147], v26 offset:1536
    ds_read_b64 v[32:33], v27 offset:2560
    ds_read_b128 v[148:151], v26 offset:0
    ds_read_b64 v[34:35], v27 offset:1024
    ds_read2st64_b64 v[156:159], v11 offset0:0 offset1:1
    s_mov_b64 exec, s[26:27]
    ds_read_b64 v[38:39], v11 offset:1024
    s_mov_b64 exec, s[24:25]
    ds_read_b128 v[44:47], v12 offset:0
    ds_read_b128 v[48:51], v12 offset:640
    s_mov_b64 exec, -1
    ds_read2st64_b64 v[160:163], v11 offset0:10 offset1:11
    s_mov_b64 exec, s[26:27]
    ds_read_b64 v[40:41], v11 offset:6144
    s_mov_b64 exec, -1
concat_heads__sliding_block__softmax_full_mha__prompt_kernel_cjoin:
    s_waitcnt lgkmcnt(4)
    v_mfma_f32_32x32x8_bf16 v[112:127], v[38:39], v[32:33], 0
    v_mfma_f32_32x32x16_bf16 v[112:127], v[156:159], v[144:147], v[112:127]
concat_heads__sliding_block__softmax_full_mha__prompt_kernel_bpro:
    s_mov_b64 s[56:57], s[68:69]
    s_mov_b32 s58, 5242880
    s_mov_b32 s34, s75
    s_add_u32 m0, s76, 57344
    s_lshl_b32 s35, s32, 3
    s_add_u32 s35, s35, s16
    s_mul_i32 s35, s35, 3200
    s_add_u32 s39, s35, 21823488
    s_mov_b32 s47, 0
    v_min_u32 v26, 3072, v29
    s_nop 0
.p2align 3
    v_mfma_f32_32x32x8_bf16 v[128:143], v[38:39], v[34:35], 0
    s_setprio 3
    v_exp_f32 v112, v112
    v_exp_f32 v113, v113
    v_exp_f32 v114, v114
    v_exp_f32 v115, v115
    v_cvt_pk_bf16_f32 v164, v112, v113
    v_cvt_pk_bf16_f32 v165, v114, v115
    v_mfma_f32_32x32x16_bf16 v[128:143], v[156:159], v[148:151], v[128:143]
    buffer_load_dwordx4 v6, s[12:15], s34 offen sc1 lds
    s_add_u32 m0, m0, 8192
    s_add_u32 s34, s34, 8192
    v_exp_f32 v116, v116
    v_exp_f32 v117, v117
    v_exp_f32 v118, v118
    v_exp_f32 v119, v119
    v_cvt_pk_bf16_f32 v166, v116, v117
    v_cvt_pk_bf16_f32 v167, v118, v119
    v_mfma_f32_32x32x16_bf16 v[84:99], v[52:55], v[60:63], v[84:99]
    v_exp_f32 v120, v120
    v_exp_f32 v121, v121
    v_exp_f32 v122, v122
    v_exp_f32 v123, v123
    v_cvt_pk_bf16_f32 v168, v120, v121
    v_cvt_pk_bf16_f32 v169, v122, v123
    v_mfma_f32_32x32x16_bf16 v[84:99], v[56:59], v[64:67], v[84:99]
    v_exp_f32 v124, v124
    v_exp_f32 v125, v125
    v_exp_f32 v126, v126
    v_exp_f32 v127, v127
    v_cvt_pk_bf16_f32 v170, v124, v125
    v_cvt_pk_bf16_f32 v171, v126, v127
    s_waitcnt lgkmcnt(0)
    v_mfma_f32_32x32x8_bf16 v[112:127], v[40:41], v[32:33], 0
    ds_read2st64_b64 v[156:159], v11 offset0:20 offset1:21
    s_mov_b64 exec, s[26:27]
    ds_read_b64 v[38:39], v11 offset:11264
    s_mov_b64 exec, s[24:25]
    ds_read_b128 v[52:55], v12 offset:5120
    ds_read_b128 v[56:59], v12 offset:5760
    s_mov_b64 exec, -1
    v_exp_f32 v128, v128
    v_exp_f32 v129, v129
    v_exp_f32 v130, v130
    v_exp_f32 v131, v131
    v_cvt_pk_bf16_f32 v60, v128, v129
    v_cvt_pk_bf16_f32 v61, v130, v131
    v_mfma_f32_32x32x16_bf16 v[112:127], v[160:163], v[144:147], v[112:127]
    v_exp_f32 v132, v132
    v_exp_f32 v133, v133
    v_exp_f32 v134, v134
    v_exp_f32 v135, v135
    v_cvt_pk_bf16_f32 v62, v132, v133
    v_cvt_pk_bf16_f32 v63, v134, v135
    v_mfma_f32_32x32x16_bf16 v[68:83], v[44:47], v[164:167], v[68:83]
    s_cbranch_vccz L_sk_26
    buffer_store_dwordx4 v[176:179], v106, s[12:15], s51 offen sc1
    buffer_store_dwordx4 v[192:195], v107, s[12:15], s51 offen sc1
L_sk_26:
    v_exp_f32 v136, v136
    v_exp_f32 v137, v137
    v_exp_f32 v138, v138
    v_exp_f32 v139, v139
    v_cvt_pk_bf16_f32 v64, v136, v137
    v_cvt_pk_bf16_f32 v65, v138, v139
    v_mfma_f32_32x32x16_bf16 v[68:83], v[48:51], v[168:171], v[68:83]
    v_exp_f32 v140, v140
    v_exp_f32 v141, v141
    v_exp_f32 v142, v142
    v_exp_f32 v143, v143
    v_cvt_pk_bf16_f32 v66, v140, v141
    v_cvt_pk_bf16_f32 v67, v142, v143
    v_mfma_f32_32x32x8_bf16 v[128:143], v[40:41], v[34:35], 0
    v_exp_f32 v112, v112
    v_exp_f32 v113, v113
    v_exp_f32 v114, v114
    v_exp_f32 v115, v115
    v_cvt_pk_bf16_f32 v164, v112, v113
    v_cvt_pk_bf16_f32 v165, v114, v115
    v_mfma_f32_32x32x16_bf16 v[128:143], v[160:163], v[148:151], v[128:143]
    buffer_load_dwordx4 v6, s[12:15], s34 offen sc1 lds
    s_add_u32 m0, m0, 8192
    s_add_u32 s34, s34, 8192
    v_exp_f32 v116, v116
    v_exp_f32 v117, v117
    v_exp_f32 v118, v118
    v_exp_f32 v119, v119
    v_cvt_pk_bf16_f32 v166, v116, v117
    v_cvt_pk_bf16_f32 v167, v118, v119
    v_mfma_f32_32x32x16_bf16 v[84:99], v[44:47], v[60:63], v[84:99]
    v_exp_f32 v120, v120
    v_exp_f32 v121, v121
    v_exp_f32 v122, v122
    v_exp_f32 v123, v123
    v_cvt_pk_bf16_f32 v168, v120, v121
    v_cvt_pk_bf16_f32 v169, v122, v123
    v_mfma_f32_32x32x16_bf16 v[84:99], v[48:51], v[64:67], v[84:99]
    v_exp_f32 v124, v124
    v_exp_f32 v125, v125
    v_exp_f32 v126, v126
    v_exp_f32 v127, v127
    v_cvt_pk_bf16_f32 v170, v124, v125
    v_cvt_pk_bf16_f32 v171, v126, v127
    s_waitcnt lgkmcnt(0)
    v_mfma_f32_32x32x8_bf16 v[112:127], v[38:39], v[32:33], 0
    ds_read2st64_b64 v[160:163], v11 offset0:30 offset1:31
    s_mov_b64 exec, s[26:27]
    ds_read_b64 v[40:41], v11 offset:16384
    s_mov_b64 exec, s[24:25]
    ds_read_b128 v[44:47], v12 offset:10240
    ds_read_b128 v[48:51], v12 offset:10880
    s_mov_b64 exec, -1
    v_exp_f32 v128, v128
    v_exp_f32 v129, v129
    v_exp_f32 v130, v130
    v_exp_f32 v131, v131
    v_cvt_pk_bf16_f32 v60, v128, v129
    v_cvt_pk_bf16_f32 v61, v130, v131
    v_mfma_f32_32x32x16_bf16 v[112:127], v[156:159], v[144:147], v[112:127]
    v_exp_f32 v132, v132
    v_exp_f32 v133, v133
    v_exp_f32 v134, v134
    v_exp_f32 v135, v135
    v_cvt_pk_bf16_f32 v62, v132, v133
    v_cvt_pk_bf16_f32 v63, v134, v135
    v_mfma_f32_32x32x16_bf16 v[68:83], v[52:55], v[164:167], v[68:83]
    s_cbranch_vccz L_sk_27
    buffer_store_dwordx4 v[208:211], v108, s[12:15], s51 offen sc1
    buffer_store_dwordx4 v[224:227], v109, s[12:15], s51 offen sc1
L_sk_27:
    v_exp_f32 v136, v136
    v_exp_f32 v137, v137
    v_exp_f32 v138, v138
    v_exp_f32 v139, v139
    v_cvt_pk_bf16_f32 v64, v136, v137
    v_cvt_pk_bf16_f32 v65, v138, v139
    v_mfma_f32_32x32x16_bf16 v[68:83], v[56:59], v[168:171], v[68:83]
    v_exp_f32 v140, v140
    v_exp_f32 v141, v141
    v_exp_f32 v142, v142
    v_exp_f32 v143, v143
    v_cvt_pk_bf16_f32 v66, v140, v141
    v_cvt_pk_bf16_f32 v67, v142, v143
    v_mfma_f32_32x32x8_bf16 v[128:143], v[38:39], v[34:35], 0
    v_exp_f32 v112, v112
    v_exp_f32 v113, v113
    v_exp_f32 v114, v114
    v_exp_f32 v115, v115
    v_cvt_pk_bf16_f32 v164, v112, v113
    v_cvt_pk_bf16_f32 v165, v114, v115
    v_mfma_f32_32x32x16_bf16 v[128:143], v[156:159], v[148:151], v[128:143]
    buffer_load_dwordx4 v6, s[12:15], s34 offen sc1 lds
    s_add_u32 m0, m0, 8192
    s_add_u32 s34, s34, 8192
    v_exp_f32 v116, v116
    v_exp_f32 v117, v117
    v_exp_f32 v118, v118
    v_exp_f32 v119, v119
    v_cvt_pk_bf16_f32 v166, v116, v117
    v_cvt_pk_bf16_f32 v167, v118, v119
    v_mfma_f32_32x32x16_bf16 v[84:99], v[52:55], v[60:63], v[84:99]
    v_exp_f32 v120, v120
    v_exp_f32 v121, v121
    v_exp_f32 v122, v122
    v_exp_f32 v123, v123
    v_cvt_pk_bf16_f32 v168, v120, v121
    v_cvt_pk_bf16_f32 v169, v122, v123
    v_mfma_f32_32x32x16_bf16 v[84:99], v[56:59], v[64:67], v[84:99]
    v_exp_f32 v124, v124
    v_exp_f32 v125, v125
    v_exp_f32 v126, v126
    v_exp_f32 v127, v127
    v_cvt_pk_bf16_f32 v170, v124, v125
    v_cvt_pk_bf16_f32 v171, v126, v127
    s_waitcnt lgkmcnt(0)
    v_mfma_f32_32x32x8_bf16 v[112:127], v[40:41], v[32:33], 0
    ds_read2st64_b64 v[156:159], v11 offset0:40 offset1:41
    s_mov_b64 exec, s[26:27]
    ds_read_b64 v[38:39], v11 offset:21504
    s_mov_b64 exec, s[24:25]
    ds_read_b128 v[52:55], v12 offset:15360
    ds_read_b128 v[56:59], v12 offset:16000
    s_mov_b64 exec, -1
    v_exp_f32 v128, v128
    v_exp_f32 v129, v129
    v_exp_f32 v130, v130
    v_exp_f32 v131, v131
    v_cvt_pk_bf16_f32 v60, v128, v129
    v_cvt_pk_bf16_f32 v61, v130, v131
    v_mfma_f32_32x32x16_bf16 v[112:127], v[160:163], v[144:147], v[112:127]
    v_exp_f32 v132, v132
    v_exp_f32 v133, v133
    v_exp_f32 v134, v134
    v_exp_f32 v135, v135
    v_cvt_pk_bf16_f32 v62, v132, v133
    v_cvt_pk_bf16_f32 v63, v134, v135
    v_mfma_f32_32x32x16_bf16 v[68:83], v[44:47], v[164:167], v[68:83]
    s_cbranch_vccz L_sk_28
    buffer_store_dwordx4 v[184:187], v106, s[12:15], s53 offen sc1
    buffer_store_dwordx4 v[200:203], v107, s[12:15], s53 offen sc1
L_sk_28:
    v_exp_f32 v136, v136
    v_exp_f32 v137, v137
    v_exp_f32 v138, v138
    v_exp_f32 v139, v139
    v_cvt_pk_bf16_f32 v64, v136, v137
    v_cvt_pk_bf16_f32 v65, v138, v139
    v_mfma_f32_32x32x16_bf16 v[68:83], v[48:51], v[168:171], v[68:83]
    v_exp_f32 v140, v140
    v_exp_f32 v141, v141
    v_exp_f32 v142, v142
    v_exp_f32 v143, v143
    v_cvt_pk_bf16_f32 v66, v140, v141
    v_cvt_pk_bf16_f32 v67, v142, v143
    v_mfma_f32_32x32x8_bf16 v[128:143], v[40:41], v[34:35], 0
    v_exp_f32 v112, v112
    v_exp_f32 v113, v113
    v_exp_f32 v114, v114
    v_exp_f32 v115, v115
    v_cvt_pk_bf16_f32 v164, v112, v113
    v_cvt_pk_bf16_f32 v165, v114, v115
    v_mfma_f32_32x32x16_bf16 v[128:143], v[160:163], v[148:151], v[128:143]
    buffer_load_dwordx4 v6, s[12:15], s34 offen sc1 lds
    s_add_u32 m0, m0, 8192
    s_add_u32 s34, s34, 8192
    v_exp_f32 v116, v116
    v_exp_f32 v117, v117
    v_exp_f32 v118, v118
    v_exp_f32 v119, v119
    v_cvt_pk_bf16_f32 v166, v116, v117
    v_cvt_pk_bf16_f32 v167, v118, v119
    v_mfma_f32_32x32x16_bf16 v[84:99], v[44:47], v[60:63], v[84:99]
    v_exp_f32 v120, v120
    v_exp_f32 v121, v121
    v_exp_f32 v122, v122
    v_exp_f32 v123, v123
    v_cvt_pk_bf16_f32 v168, v120, v121
    v_cvt_pk_bf16_f32 v169, v122, v123
    v_mfma_f32_32x32x16_bf16 v[84:99], v[48:51], v[64:67], v[84:99]
    v_exp_f32 v124, v124
    v_exp_f32 v125, v125
    v_exp_f32 v126, v126
    v_exp_f32 v127, v127
    v_cvt_pk_bf16_f32 v170, v124, v125
    v_cvt_pk_bf16_f32 v171, v126, v127
    s_waitcnt lgkmcnt(0)
    v_mfma_f32_32x32x8_bf16 v[112:127], v[38:39], v[32:33], 0
    ds_read2st64_b64 v[160:163], v11 offset0:50 offset1:51
    s_mov_b64 exec, s[26:27]
    ds_read_b64 v[40:41], v11 offset:26624
    s_mov_b64 exec, s[24:25]
    ds_read_b128 v[44:47], v12 offset:20480
    ds_read_b128 v[48:51], v12 offset:21120
    s_mov_b64 exec, -1
    v_exp_f32 v128, v128
    v_exp_f32 v129, v129
    v_exp_f32 v130, v130
    v_exp_f32 v131, v131
    v_cvt_pk_bf16_f32 v60, v128, v129
    v_cvt_pk_bf16_f32 v61, v130, v131
    v_mfma_f32_32x32x16_bf16 v[112:127], v[156:159], v[144:147], v[112:127]
    v_exp_f32 v132, v132
    v_exp_f32 v133, v133
    v_exp_f32 v134, v134
    v_exp_f32 v135, v135
    v_cvt_pk_bf16_f32 v62, v132, v133
    v_cvt_pk_bf16_f32 v63, v134, v135
    v_mfma_f32_32x32x16_bf16 v[68:83], v[52:55], v[164:167], v[68:83]
    s_cbranch_vccz L_sk_29
    buffer_store_dwordx4 v[216:219], v108, s[12:15], s53 offen sc1
    buffer_store_dwordx4 v[232:235], v109, s[12:15], s53 offen sc1
L_sk_29:
    v_exp_f32 v136, v136
    v_exp_f32 v137, v137
    v_exp_f32 v138, v138
    v_exp_f32 v139, v139
    v_cvt_pk_bf16_f32 v64, v136, v137
    v_cvt_pk_bf16_f32 v65, v138, v139
    v_mfma_f32_32x32x16_bf16 v[68:83], v[56:59], v[168:171], v[68:83]
    v_exp_f32 v140, v140
    v_exp_f32 v141, v141
    v_exp_f32 v142, v142
    v_exp_f32 v143, v143
    v_cvt_pk_bf16_f32 v66, v140, v141
    v_cvt_pk_bf16_f32 v67, v142, v143
    v_mfma_f32_32x32x8_bf16 v[128:143], v[38:39], v[34:35], 0
    s_setprio 2
    v_exp_f32 v112, v112
    v_exp_f32 v113, v113
    v_exp_f32 v114, v114
    v_exp_f32 v115, v115
    v_cvt_pk_bf16_f32 v164, v112, v113
    v_cvt_pk_bf16_f32 v165, v114, v115
    v_mfma_f32_32x32x16_bf16 v[128:143], v[156:159], v[148:151], v[128:143]
    buffer_load_dwordx4 v6, s[12:15], s34 offen sc1 lds
    s_add_u32 m0, m0, 8192
    s_add_u32 s34, s34, 8192
    v_exp_f32 v116, v116
    v_exp_f32 v117, v117
    v_exp_f32 v118, v118
    v_exp_f32 v119, v119
    v_cvt_pk_bf16_f32 v166, v116, v117
    v_cvt_pk_bf16_f32 v167, v118, v119
    v_mfma_f32_32x32x16_bf16 v[84:99], v[52:55], v[60:63], v[84:99]
    v_exp_f32 v120, v120
    v_exp_f32 v121, v121
    v_exp_f32 v122, v122
    v_exp_f32 v123, v123
    v_cvt_pk_bf16_f32 v168, v120, v121
    v_cvt_pk_bf16_f32 v169, v122, v123
    v_mfma_f32_32x32x16_bf16 v[84:99], v[56:59], v[64:67], v[84:99]
    v_exp_f32 v124, v124
    v_exp_f32 v125, v125
    v_exp_f32 v126, v126
    v_exp_f32 v127, v127
    v_cvt_pk_bf16_f32 v170, v124, v125
    v_cvt_pk_bf16_f32 v171, v126, v127
    s_waitcnt lgkmcnt(0)
    v_mfma_f32_32x32x8_bf16 v[112:127], v[40:41], v[32:33], 0
    ds_read2st64_b64 v[156:159], v11 offset0:60 offset1:61
    s_mov_b64 exec, s[26:27]
    ds_read_b64 v[38:39], v11 offset:31744
    s_mov_b64 exec, s[24:25]
    ds_read_b128 v[52:55], v12 offset:25600
    ds_read_b128 v[56:59], v12 offset:26240
    s_mov_b64 exec, -1
    v_exp_f32 v128, v128
    v_exp_f32 v129, v129
    v_exp_f32 v130, v130
    v_exp_f32 v131, v131
    v_cvt_pk_bf16_f32 v60, v128, v129
    v_cvt_pk_bf16_f32 v61, v130, v131
    v_mfma_f32_32x32x16_bf16 v[112:127], v[160:163], v[144:147], v[112:127]
    v_exp_f32 v132, v132
    v_exp_f32 v133, v133
    v_exp_f32 v134, v134
    v_exp_f32 v135, v135
    v_cvt_pk_bf16_f32 v62, v132, v133
    v_cvt_pk_bf16_f32 v63, v134, v135
    v_mfma_f32_32x32x16_bf16 v[68:83], v[44:47], v[164:167], v[68:83]
    v_exp_f32 v136, v136
    v_exp_f32 v137, v137
    v_exp_f32 v138, v138
    v_exp_f32 v139, v139
    v_cvt_pk_bf16_f32 v64, v136, v137
    v_cvt_pk_bf16_f32 v65, v138, v139
    v_mfma_f32_32x32x16_bf16 v[68:83], v[48:51], v[168:171], v[68:83]
    v_exp_f32 v140, v140
    v_exp_f32 v141, v141
    v_exp_f32 v142, v142
    v_exp_f32 v143, v143
    v_cvt_pk_bf16_f32 v66, v140, v141
    v_cvt_pk_bf16_f32 v67, v142, v143
    v_mfma_f32_32x32x8_bf16 v[128:143], v[40:41], v[34:35], 0
    v_exp_f32 v112, v112
    v_exp_f32 v113, v113
    v_exp_f32 v114, v114
    v_exp_f32 v115, v115
    v_cvt_pk_bf16_f32 v164, v112, v113
    v_cvt_pk_bf16_f32 v165, v114, v115
    v_mfma_f32_32x32x16_bf16 v[128:143], v[160:163], v[148:151], v[128:143]
    buffer_load_dwordx4 v6, s[12:15], s34 offen sc1 lds
    s_add_u32 m0, m0, 8192
    s_add_u32 s34, s34, 8192
    v_exp_f32 v116, v116
    v_exp_f32 v117, v117
    v_exp_f32 v118, v118
    v_exp_f32 v119, v119
    v_cvt_pk_bf16_f32 v166, v116, v117
    v_cvt_pk_bf16_f32 v167, v118, v119
    v_mfma_f32_32x32x16_bf16 v[84:99], v[44:47], v[60:63], v[84:99]
    v_exp_f32 v120, v120
    v_exp_f32 v121, v121
    v_exp_f32 v122, v122
    v_exp_f32 v123, v123
    v_cvt_pk_bf16_f32 v168, v120, v121
    v_cvt_pk_bf16_f32 v169, v122, v123
    v_mfma_f32_32x32x16_bf16 v[84:99], v[48:51], v[64:67], v[84:99]
    v_exp_f32 v124, v124
    v_exp_f32 v125, v125
    v_exp_f32 v126, v126
    v_exp_f32 v127, v127
    v_cvt_pk_bf16_f32 v170, v124, v125
    v_cvt_pk_bf16_f32 v171, v126, v127
    s_waitcnt lgkmcnt(0)
    v_mfma_f32_32x32x8_bf16 v[112:127], v[38:39], v[32:33], 0
    ds_read2st64_b64 v[160:163], v11 offset0:70 offset1:71
    s_mov_b64 exec, s[26:27]
    ds_read_b64 v[40:41], v11 offset:36864
    s_mov_b64 exec, s[24:25]
    ds_read_b128 v[44:47], v12 offset:30720
    ds_read_b128 v[48:51], v12 offset:31360
    s_mov_b64 exec, -1
    v_exp_f32 v128, v128
    v_exp_f32 v129, v129
    v_exp_f32 v130, v130
    v_exp_f32 v131, v131
    v_cvt_pk_bf16_f32 v60, v128, v129
    v_cvt_pk_bf16_f32 v61, v130, v131
    v_mfma_f32_32x32x16_bf16 v[112:127], v[156:159], v[144:147], v[112:127]
    v_exp_f32 v132, v132
    v_exp_f32 v133, v133
    v_exp_f32 v134, v134
    v_exp_f32 v135, v135
    v_cvt_pk_bf16_f32 v62, v132, v133
    v_cvt_pk_bf16_f32 v63, v134, v135
    v_mfma_f32_32x32x16_bf16 v[68:83], v[52:55], v[164:167], v[68:83]
    v_exp_f32 v136, v136
    v_exp_f32 v137, v137
    v_exp_f32 v138, v138
    v_exp_f32 v139, v139
    v_cvt_pk_bf16_f32 v64, v136, v137
    v_cvt_pk_bf16_f32 v65, v138, v139
    v_mfma_f32_32x32x16_bf16 v[68:83], v[56:59], v[168:171], v[68:83]
    v_exp_f32 v140, v140
    v_exp_f32 v141, v141
    v_exp_f32 v142, v142
    v_exp_f32 v143, v143
    v_cvt_pk_bf16_f32 v66, v140, v141
    v_cvt_pk_bf16_f32 v67, v142, v143
    v_mfma_f32_32x32x8_bf16 v[128:143], v[38:39], v[34:35], 0
    s_setprio 1
    v_exp_f32 v112, v112
    v_exp_f32 v113, v113
    v_exp_f32 v114, v114
    v_exp_f32 v115, v115
    v_cvt_pk_bf16_f32 v164, v112, v113
    v_cvt_pk_bf16_f32 v165, v114, v115
    v_mfma_f32_32x32x16_bf16 v[128:143], v[156:159], v[148:151], v[128:143]
    buffer_load_dwordx4 v6, s[12:15], s34 offen sc1 lds
    s_add_u32 m0, m0, 8192
    s_add_u32 s34, s34, 8192
    v_exp_f32 v116, v116
    v_exp_f32 v117, v117
    v_exp_f32 v118, v118
    v_exp_f32 v119, v119
    v_cvt_pk_bf16_f32 v166, v116, v117
    v_cvt_pk_bf16_f32 v167, v118, v119
    v_mfma_f32_32x32x16_bf16 v[84:99], v[52:55], v[60:63], v[84:99]
    v_exp_f32 v120, v120
    v_exp_f32 v121, v121
    v_exp_f32 v122, v122
    v_exp_f32 v123, v123
    v_cvt_pk_bf16_f32 v168, v120, v121
    v_cvt_pk_bf16_f32 v169, v122, v123
    v_mfma_f32_32x32x16_bf16 v[84:99], v[56:59], v[64:67], v[84:99]
    v_exp_f32 v124, v124
    v_exp_f32 v125, v125
    v_exp_f32 v126, v126
    v_exp_f32 v127, v127
    v_cvt_pk_bf16_f32 v170, v124, v125
    v_cvt_pk_bf16_f32 v171, v126, v127
    s_waitcnt lgkmcnt(0)
    v_mfma_f32_32x32x8_bf16 v[112:127], v[40:41], v[32:33], 0
    ds_read2st64_b64 v[156:159], v11 offset0:80 offset1:81
    s_mov_b64 exec, s[26:27]
    ds_read_b64 v[38:39], v11 offset:41984
    s_mov_b64 exec, s[24:25]
    ds_read_b128 v[52:55], v12 offset:35840
    ds_read_b128 v[56:59], v12 offset:36480
    s_mov_b64 exec, -1
    v_exp_f32 v128, v128
    v_exp_f32 v129, v129
    v_exp_f32 v130, v130
    v_exp_f32 v131, v131
    v_cvt_pk_bf16_f32 v60, v128, v129
    v_cvt_pk_bf16_f32 v61, v130, v131
    v_mfma_f32_32x32x16_bf16 v[112:127], v[160:163], v[144:147], v[112:127]
    v_exp_f32 v132, v132
    v_exp_f32 v133, v133
    v_exp_f32 v134, v134
    v_exp_f32 v135, v135
    v_cvt_pk_bf16_f32 v62, v132, v133
    v_cvt_pk_bf16_f32 v63, v134, v135
    v_mfma_f32_32x32x16_bf16 v[68:83], v[44:47], v[164:167], v[68:83]
    v_exp_f32 v136, v136
    v_exp_f32 v137, v137
    v_exp_f32 v138, v138
    v_exp_f32 v139, v139
    v_cvt_pk_bf16_f32 v64, v136, v137
    v_cvt_pk_bf16_f32 v65, v138, v139
    v_mfma_f32_32x32x16_bf16 v[68:83], v[48:51], v[168:171], v[68:83]
    v_exp_f32 v140, v140
    v_exp_f32 v141, v141
    v_exp_f32 v142, v142
    v_exp_f32 v143, v143
    v_cvt_pk_bf16_f32 v66, v140, v141
    v_cvt_pk_bf16_f32 v67, v142, v143
    v_mfma_f32_32x32x8_bf16 v[128:143], v[40:41], v[34:35], 0
    s_setprio 0
    v_exp_f32 v112, v112
    v_exp_f32 v113, v113
    v_exp_f32 v114, v114
    v_exp_f32 v115, v115
    v_cvt_pk_bf16_f32 v164, v112, v113
    v_cvt_pk_bf16_f32 v165, v114, v115
    v_mfma_f32_32x32x16_bf16 v[128:143], v[160:163], v[148:151], v[128:143]
    buffer_load_dwordx4 v6, s[12:15], s34 offen sc1 lds
    s_add_u32 m0, m0, 8192
    s_add_u32 s34, s34, 8192
    v_exp_f32 v116, v116
    v_exp_f32 v117, v117
    v_exp_f32 v118, v118
    v_exp_f32 v119, v119
    v_cvt_pk_bf16_f32 v166, v116, v117
    v_cvt_pk_bf16_f32 v167, v118, v119
    v_mfma_f32_32x32x16_bf16 v[84:99], v[44:47], v[60:63], v[84:99]
    v_exp_f32 v120, v120
    v_exp_f32 v121, v121
    v_exp_f32 v122, v122
    v_exp_f32 v123, v123
    v_cvt_pk_bf16_f32 v168, v120, v121
    v_cvt_pk_bf16_f32 v169, v122, v123
    v_mfma_f32_32x32x16_bf16 v[84:99], v[48:51], v[64:67], v[84:99]
    v_exp_f32 v124, v124
    v_exp_f32 v125, v125
    v_exp_f32 v126, v126
    v_exp_f32 v127, v127
    v_cvt_pk_bf16_f32 v170, v124, v125
    v_cvt_pk_bf16_f32 v171, v126, v127
    s_waitcnt lgkmcnt(0)
    v_mfma_f32_32x32x8_bf16 v[112:127], v[38:39], v[32:33], 0
    ds_read2st64_b64 v[160:163], v11 offset0:90 offset1:91
    s_mov_b64 exec, s[26:27]
    ds_read_b64 v[40:41], v11 offset:47104
    s_mov_b64 exec, s[24:25]
    ds_read_b128 v[44:47], v12 offset:40960
    ds_read_b128 v[48:51], v12 offset:41600
    s_mov_b64 exec, -1
    v_exp_f32 v128, v128
    v_exp_f32 v129, v129
    v_exp_f32 v130, v130
    v_exp_f32 v131, v131
    v_cvt_pk_bf16_f32 v60, v128, v129
    v_cvt_pk_bf16_f32 v61, v130, v131
    v_mfma_f32_32x32x16_bf16 v[112:127], v[156:159], v[144:147], v[112:127]
    v_exp_f32 v132, v132
    v_exp_f32 v133, v133
    v_exp_f32 v134, v134
    v_exp_f32 v135, v135
    v_cvt_pk_bf16_f32 v62, v132, v133
    v_cvt_pk_bf16_f32 v63, v134, v135
    v_mfma_f32_32x32x16_bf16 v[68:83], v[52:55], v[164:167], v[68:83]
    v_exp_f32 v136, v136
    v_exp_f32 v137, v137
    v_exp_f32 v138, v138
    v_exp_f32 v139, v139
    v_cvt_pk_bf16_f32 v64, v136, v137
    v_cvt_pk_bf16_f32 v65, v138, v139
    v_mfma_f32_32x32x16_bf16 v[68:83], v[56:59], v[168:171], v[68:83]
    v_exp_f32 v140, v140
    v_exp_f32 v141, v141
    v_exp_f32 v142, v142
    v_exp_f32 v143, v143
    v_cvt_pk_bf16_f32 v66, v140, v141
    v_cvt_pk_bf16_f32 v67, v142, v143
    v_add_u32 v11, 40960, v11
    v_add_u32 v12, 40960, v12
    v_mov_b32 v3, 1
    s_cmp_lt_u32 s32, 30
    s_cselect_b32 s44, s16, 1
    s_waitcnt vmcnt(4)
    s_barrier
    s_cmp_lg_u32 s44, 0
    s_cbranch_scc1 L_np_30
    s_mov_b64 exec, s[94:95]
    buffer_atomic_add v3, v29, s[12:15], s93 offen sc1
    s_mov_b64 exec, -1
L_np_30:
.p2align 3
    v_mfma_f32_32x32x8_bf16 v[128:143], v[38:39], v[34:35], 0
    s_setprio 3
    v_exp_f32 v112, v112
    v_exp_f32 v113, v113
    v_exp_f32 v114, v114
    v_exp_f32 v115, v115
    v_cvt_pk_bf16_f32 v164, v112, v113
    v_cvt_pk_bf16_f32 v165, v114, v115
    v_mfma_f32_32x32x16_bf16 v[128:143], v[156:159], v[148:151], v[128:143]
    buffer_load_dwordx4 v6, s[12:15], s34 offen sc1 lds
    s_add_u32 m0, m0, 8192
    s_add_u32 s34, s34, 8192
    v_exp_f32 v116, v116
    v_exp_f32 v117, v117
    v_exp_f32 v118, v118
    v_exp_f32 v119, v119
    v_cvt_pk_bf16_f32 v166, v116, v117
    v_cvt_pk_bf16_f32 v167, v118, v119
    v_mfma_f32_32x32x16_bf16 v[84:99], v[52:55], v[60:63], v[84:99]
    v_exp_f32 v120, v120
    v_exp_f32 v121, v121
    v_exp_f32 v122, v122
    v_exp_f32 v123, v123
    v_cvt_pk_bf16_f32 v168, v120, v121
    v_cvt_pk_bf16_f32 v169, v122, v123
    v_mfma_f32_32x32x16_bf16 v[84:99], v[56:59], v[64:67], v[84:99]
    v_exp_f32 v124, v124
    v_exp_f32 v125, v125
    v_exp_f32 v126, v126
    v_exp_f32 v127, v127
    v_cvt_pk_bf16_f32 v170, v124, v125
    v_cvt_pk_bf16_f32 v171, v126, v127
    s_waitcnt lgkmcnt(0)
    v_mfma_f32_32x32x8_bf16 v[112:127], v[40:41], v[32:33], 0
    ds_read2st64_b64 v[156:159], v11 offset0:20 offset1:21
    s_mov_b64 exec, s[26:27]
    ds_read_b64 v[38:39], v11 offset:11264
    s_mov_b64 exec, s[24:25]
    ds_read_b128 v[52:55], v12 offset:5120
    ds_read_b128 v[56:59], v12 offset:5760
    s_mov_b64 exec, -1
    v_exp_f32 v128, v128
    v_exp_f32 v129, v129
    v_exp_f32 v130, v130
    v_exp_f32 v131, v131
    v_cvt_pk_bf16_f32 v60, v128, v129
    v_cvt_pk_bf16_f32 v61, v130, v131
    v_mfma_f32_32x32x16_bf16 v[112:127], v[160:163], v[144:147], v[112:127]
    v_exp_f32 v132, v132
    v_exp_f32 v133, v133
    v_exp_f32 v134, v134
    v_exp_f32 v135, v135
    v_cvt_pk_bf16_f32 v62, v132, v133
    v_cvt_pk_bf16_f32 v63, v134, v135
    v_mfma_f32_32x32x16_bf16 v[68:83], v[44:47], v[164:167], v[68:83]
    buffer_load_dwordx4 v6, s[12:15], s34 offen sc1 lds
    s_add_u32 m0, m0, 8192
    s_add_u32 s34, s34, 8192
    v_exp_f32 v136, v136
    v_exp_f32 v137, v137
    v_exp_f32 v138, v138
    v_exp_f32 v139, v139
    v_cvt_pk_bf16_f32 v64, v136, v137
    v_cvt_pk_bf16_f32 v65, v138, v139
    v_mfma_f32_32x32x16_bf16 v[68:83], v[48:51], v[168:171], v[68:83]
    v_exp_f32 v140, v140
    v_exp_f32 v141, v141
    v_exp_f32 v142, v142
    v_exp_f32 v143, v143
    v_cvt_pk_bf16_f32 v66, v140, v141
    v_cvt_pk_bf16_f32 v67, v142, v143
    v_mfma_f32_32x32x8_bf16 v[128:143], v[40:41], v[34:35], 0
    v_exp_f32 v112, v112
    v_exp_f32 v113, v113
    v_exp_f32 v114, v114
    v_exp_f32 v115, v115
    v_cvt_pk_bf16_f32 v164, v112, v113
    v_cvt_pk_bf16_f32 v165, v114, v115
    v_mfma_f32_32x32x16_bf16 v[128:143], v[160:163], v[148:151], v[128:143]
    buffer_load_dwordx4 v6, s[12:15], s34 offen sc1 lds
    s_add_u32 m0, m0, 8192
    s_add_u32 s34, s34, 8192
    v_exp_f32 v116, v116
    v_exp_f32 v117, v117
    v_exp_f32 v118, v118
    v_exp_f32 v119, v119
    v_cvt_pk_bf16_f32 v166, v116, v117
    v_cvt_pk_bf16_f32 v167, v118, v119
    v_mfma_f32_32x32x16_bf16 v[84:99], v[44:47], v[60:63], v[84:99]
    v_exp_f32 v120, v120
    v_exp_f32 v121, v121
    v_exp_f32 v122, v122
    v_exp_f32 v123, v123
    v_cvt_pk_bf16_f32 v168, v120, v121
    v_cvt_pk_bf16_f32 v169, v122, v123
    v_mfma_f32_32x32x16_bf16 v[84:99], v[48:51], v[64:67], v[84:99]
    v_exp_f32 v124, v124
    v_exp_f32 v125, v125
    v_exp_f32 v126, v126
    v_exp_f32 v127, v127
    v_cvt_pk_bf16_f32 v170, v124, v125
    v_cvt_pk_bf16_f32 v171, v126, v127
    s_waitcnt lgkmcnt(0)
    v_mfma_f32_32x32x8_bf16 v[112:127], v[38:39], v[32:33], 0
    ds_read2st64_b64 v[160:163], v11 offset0:30 offset1:31
    s_mov_b64 exec, s[26:27]
    ds_read_b64 v[40:41], v11 offset:16384
    s_mov_b64 exec, s[24:25]
    ds_read_b128 v[44:47], v12 offset:10240
    ds_read_b128 v[48:51], v12 offset:10880
    s_mov_b64 exec, -1
    v_exp_f32 v128, v128
    v_exp_f32 v129, v129
    v_exp_f32 v130, v130
    v_exp_f32 v131, v131
    v_cvt_pk_bf16_f32 v60, v128, v129
    v_cvt_pk_bf16_f32 v61, v130, v131
    v_mfma_f32_32x32x16_bf16 v[112:127], v[156:159], v[144:147], v[112:127]
    v_exp_f32 v132, v132
    v_exp_f32 v133, v133
    v_exp_f32 v134, v134
    v_exp_f32 v135, v135
    v_cvt_pk_bf16_f32 v62, v132, v133
    v_cvt_pk_bf16_f32 v63, v134, v135
    v_mfma_f32_32x32x16_bf16 v[68:83], v[52:55], v[164:167], v[68:83]
    buffer_load_dwordx4 v6, s[12:15], s34 offen sc1 lds
    s_add_u32 m0, m0, 8192
    s_add_u32 s34, s34, 8192
    v_exp_f32 v136, v136
    v_exp_f32 v137, v137
    v_exp_f32 v138, v138
    v_exp_f32 v139, v139
    v_cvt_pk_bf16_f32 v64, v136, v137
    v_cvt_pk_bf16_f32 v65, v138, v139
    v_mfma_f32_32x32x16_bf16 v[68:83], v[56:59], v[168:171], v[68:83]
    v_exp_f32 v140, v140
    v_exp_f32 v141, v141
    v_exp_f32 v142, v142
    v_exp_f32 v143, v143
    v_cvt_pk_bf16_f32 v66, v140, v141
    v_cvt_pk_bf16_f32 v67, v142, v143
    v_mfma_f32_32x32x8_bf16 v[128:143], v[38:39], v[34:35], 0
    v_exp_f32 v112, v112
    v_exp_f32 v113, v113
    v_exp_f32 v114, v114
    v_exp_f32 v115, v115
    v_cvt_pk_bf16_f32 v164, v112, v113
    v_cvt_pk_bf16_f32 v165, v114, v115
    v_mfma_f32_32x32x16_bf16 v[128:143], v[156:159], v[148:151], v[128:143]
    buffer_load_dwordx4 v6, s[12:15], s34 offen sc1 lds
    s_add_u32 m0, m0, 8192
    s_add_u32 s34, s34, 8192
    v_exp_f32 v116, v116
    v_exp_f32 v117, v117
    v_exp_f32 v118, v118
    v_exp_f32 v119, v119
    v_cvt_pk_bf16_f32 v166, v116, v117
    v_cvt_pk_bf16_f32 v167, v118, v119
    v_mfma_f32_32x32x16_bf16 v[84:99], v[52:55], v[60:63], v[84:99]
    v_exp_f32 v120, v120
    v_exp_f32 v121, v121
    v_exp_f32 v122, v122
    v_exp_f32 v123, v123
    v_cvt_pk_bf16_f32 v168, v120, v121
    v_cvt_pk_bf16_f32 v169, v122, v123
    v_mfma_f32_32x32x16_bf16 v[84:99], v[56:59], v[64:67], v[84:99]
    v_exp_f32 v124, v124
    v_exp_f32 v125, v125
    v_exp_f32 v126, v126
    v_exp_f32 v127, v127
    v_cvt_pk_bf16_f32 v170, v124, v125
    v_cvt_pk_bf16_f32 v171, v126, v127
    s_waitcnt lgkmcnt(0)
    v_mfma_f32_32x32x8_bf16 v[112:127], v[40:41], v[32:33], 0
    ds_read2st64_b64 v[156:159], v11 offset0:40 offset1:41
    s_mov_b64 exec, s[26:27]
    ds_read_b64 v[38:39], v11 offset:21504
    s_mov_b64 exec, s[24:25]
    ds_read_b128 v[52:55], v12 offset:15360
    ds_read_b128 v[56:59], v12 offset:16000
    s_mov_b64 exec, -1
    v_exp_f32 v128, v128
    v_exp_f32 v129, v129
    v_exp_f32 v130, v130
    v_exp_f32 v131, v131
    v_cvt_pk_bf16_f32 v60, v128, v129
    v_cvt_pk_bf16_f32 v61, v130, v131
    v_mfma_f32_32x32x16_bf16 v[112:127], v[160:163], v[144:147], v[112:127]
    v_exp_f32 v132, v132
    v_exp_f32 v133, v133
    v_exp_f32 v134, v134
    v_exp_f32 v135, v135
    v_cvt_pk_bf16_f32 v62, v132, v133
    v_cvt_pk_bf16_f32 v63, v134, v135
    v_mfma_f32_32x32x16_bf16 v[68:83], v[44:47], v[164:167], v[68:83]
    v_exp_f32 v136, v136
    v_exp_f32 v137, v137
    v_exp_f32 v138, v138
    v_exp_f32 v139, v139
    v_cvt_pk_bf16_f32 v64, v136, v137
    v_cvt_pk_bf16_f32 v65, v138, v139
    v_mfma_f32_32x32x16_bf16 v[68:83], v[48:51], v[168:171], v[68:83]
    v_exp_f32 v140, v140
    v_exp_f32 v141, v141
    v_exp_f32 v142, v142
    v_exp_f32 v143, v143
    v_cvt_pk_bf16_f32 v66, v140, v141
    v_cvt_pk_bf16_f32 v67, v142, v143
    v_mfma_f32_32x32x8_bf16 v[128:143], v[40:41], v[34:35], 0
    v_exp_f32 v112, v112
    v_exp_f32 v113, v113
    v_exp_f32 v114, v114
    v_exp_f32 v115, v115
    v_cvt_pk_bf16_f32 v164, v112, v113
    v_cvt_pk_bf16_f32 v165, v114, v115
    v_mfma_f32_32x32x16_bf16 v[128:143], v[160:163], v[148:151], v[128:143]
    buffer_load_dword v17, v22, s[12:15], s97 offen sc1
    v_exp_f32 v116, v116
    v_exp_f32 v117, v117
    v_exp_f32 v118, v118
    v_exp_f32 v119, v119
    v_cvt_pk_bf16_f32 v166, v116, v117
    v_cvt_pk_bf16_f32 v167, v118, v119
    v_mfma_f32_32x32x16_bf16 v[84:99], v[44:47], v[60:63], v[84:99]
    v_exp_f32 v120, v120
    v_exp_f32 v121, v121
    v_exp_f32 v122, v122
    v_exp_f32 v123, v123
    v_cvt_pk_bf16_f32 v168, v120, v121
    v_cvt_pk_bf16_f32 v169, v122, v123
    v_mfma_f32_32x32x16_bf16 v[84:99], v[48:51], v[64:67], v[84:99]
    v_exp_f32 v124, v124
    v_exp_f32 v125, v125
    v_exp_f32 v126, v126
    v_exp_f32 v127, v127
    v_cvt_pk_bf16_f32 v170, v124, v125
    v_cvt_pk_bf16_f32 v171, v126, v127
    s_waitcnt lgkmcnt(0)
    v_mfma_f32_32x32x8_bf16 v[112:127], v[38:39], v[32:33], 0
    ds_read2st64_b64 v[160:163], v11 offset0:50 offset1:51
    s_mov_b64 exec, s[26:27]
    ds_read_b64 v[40:41], v11 offset:26624
    s_mov_b64 exec, s[24:25]
    ds_read_b128 v[44:47], v12 offset:20480
    ds_read_b128 v[48:51], v12 offset:21120
    s_mov_b64 exec, -1
    v_exp_f32 v128, v128
    v_exp_f32 v129, v129
    v_exp_f32 v130, v130
    v_exp_f32 v131, v131
    v_cvt_pk_bf16_f32 v60, v128, v129
    v_cvt_pk_bf16_f32 v61, v130, v131
    v_mfma_f32_32x32x16_bf16 v[112:127], v[156:159], v[144:147], v[112:127]
    v_exp_f32 v132, v132
    v_exp_f32 v133, v133
    v_exp_f32 v134, v134
    v_exp_f32 v135, v135
    v_cvt_pk_bf16_f32 v62, v132, v133
    v_cvt_pk_bf16_f32 v63, v134, v135
    v_mfma_f32_32x32x16_bf16 v[68:83], v[52:55], v[164:167], v[68:83]
    v_exp_f32 v136, v136
    v_exp_f32 v137, v137
    v_exp_f32 v138, v138
    v_exp_f32 v139, v139
    v_cvt_pk_bf16_f32 v64, v136, v137
    v_cvt_pk_bf16_f32 v65, v138, v139
    v_mfma_f32_32x32x16_bf16 v[68:83], v[56:59], v[168:171], v[68:83]
    v_exp_f32 v140, v140
    v_exp_f32 v141, v141
    v_exp_f32 v142, v142
    v_exp_f32 v143, v143
    v_cvt_pk_bf16_f32 v66, v140, v141
    v_cvt_pk_bf16_f32 v67, v142, v143
    v_mfma_f32_32x32x8_bf16 v[128:143], v[38:39], v[34:35], 0
    s_setprio 2
    v_exp_f32 v112, v112
    v_exp_f32 v113, v113
    v_exp_f32 v114, v114
    v_exp_f32 v115, v115
    v_cvt_pk_bf16_f32 v164, v112, v113
    v_cvt_pk_bf16_f32 v165, v114, v115
    v_mfma_f32_32x32x16_bf16 v[128:143], v[156:159], v[148:151], v[128:143]
    s_waitcnt vmcnt(0)
    v_cmp_ne_u32 vcc, v23, v17
    s_mov_b32 s34, s78
    s_mov_b32 m0, s76
    s_cbranch_vccnz L_waitA_31
L_okA_32:
    buffer_load_dwordx4 v6, s[12:15], s34 offen sc1 lds
    s_add_u32 m0, m0, 8192
    s_add_u32 s34, s34, 8192
    v_exp_f32 v116, v116
    v_exp_f32 v117, v117
    v_exp_f32 v118, v118
    v_exp_f32 v119, v119
    v_cvt_pk_bf16_f32 v166, v116, v117
    v_cvt_pk_bf16_f32 v167, v118, v119
    v_mfma_f32_32x32x16_bf16 v[84:99], v[52:55], v[60:63], v[84:99]
    v_exp_f32 v120, v120
    v_exp_f32 v121, v121
    v_exp_f32 v122, v122
    v_exp_f32 v123, v123
    v_cvt_pk_bf16_f32 v168, v120, v121
    v_cvt_pk_bf16_f32 v169, v122, v123
    v_mfma_f32_32x32x16_bf16 v[84:99], v[56:59], v[64:67], v[84:99]
    buffer_load_dwordx4 v6, s[12:15], s34 offen sc1 lds
    s_add_u32 m0, m0, 8192
    s_add_u32 s34, s34, 8192
    v_exp_f32 v124, v124
    v_exp_f32 v125, v125
    v_exp_f32 v126, v126
    v_exp_f32 v127, v127
    v_cvt_pk_bf16_f32 v170, v124, v125
    v_cvt_pk_bf16_f32 v171, v126, v127
    s_waitcnt lgkmcnt(0)
    v_mfma_f32_32x32x8_bf16 v[112:127], v[40:41], v[32:33], 0
    ds_read2st64_b64 v[156:159], v11 offset0:60 offset1:61
    s_mov_b64 exec, s[26:27]
    ds_read_b64 v[38:39], v11 offset:31744
    s_mov_b64 exec, s[24:25]
    ds_read_b128 v[52:55], v12 offset:25600
    ds_read_b128 v[56:59], v12 offset:26240
    s_mov_b64 exec, -1
    v_exp_f32 v128, v128
    v_exp_f32 v129, v129
    v_exp_f32 v130, v130
    v_exp_f32 v131, v131
    v_cvt_pk_bf16_f32 v60, v128, v129
    v_cvt_pk_bf16_f32 v61, v130, v131
    v_mfma_f32_32x32x16_bf16 v[112:127], v[160:163], v[144:147], v[112:127]
    buffer_load_dwordx2 v[152:153], v8, s[12:15], s77 offen sc1
    buffer_load_dwordx2 v[154:155], v8, s[12:15], s77 offen offset:512 sc1
    buffer_load_dwordx2 v[36:37], v9, s[12:15], s77 offen sc1
    v_exp_f32 v132, v132
    v_exp_f32 v133, v133
    v_exp_f32 v134, v134
    v_exp_f32 v135, v135
    v_cvt_pk_bf16_f32 v62, v132, v133
    v_cvt_pk_bf16_f32 v63, v134, v135
    v_mfma_f32_32x32x16_bf16 v[68:83], v[44:47], v[164:167], v[68:83]
    buffer_load_dwordx4 v6, s[12:15], s34 offen sc1 lds
    s_add_u32 m0, m0, 8192
    s_add_u32 s34, s34, 8192
    v_exp_f32 v136, v136
    v_exp_f32 v137, v137
    v_exp_f32 v138, v138
    v_exp_f32 v139, v139
    v_cvt_pk_bf16_f32 v64, v136, v137
    v_cvt_pk_bf16_f32 v65, v138, v139
    v_mfma_f32_32x32x16_bf16 v[68:83], v[48:51], v[168:171], v[68:83]
    v_exp_f32 v140, v140
    v_exp_f32 v141, v141
    v_exp_f32 v142, v142
    v_exp_f32 v143, v143
    v_cvt_pk_bf16_f32 v66, v140, v141
    v_cvt_pk_bf16_f32 v67, v142, v143
    v_mfma_f32_32x32x8_bf16 v[128:143], v[40:41], v[34:35], 0
    v_exp_f32 v112, v112
    v_exp_f32 v113, v113
    v_exp_f32 v114, v114
    v_exp_f32 v115, v115
    v_cvt_pk_bf16_f32 v164, v112, v113
    v_cvt_pk_bf16_f32 v165, v114, v115
    v_mfma_f32_32x32x16_bf16 v[128:143], v[160:163], v[148:151], v[128:143]
    buffer_load_dwordx4 v6, s[12:15], s34 offen sc1 lds
    s_add_u32 m0, m0, 8192
    s_add_u32 s34, s34, 8192
    v_exp_f32 v116, v116
    v_exp_f32 v117, v117
    v_exp_f32 v118, v118
    v_exp_f32 v119, v119
    v_cvt_pk_bf16_f32 v166, v116, v117
    v_cvt_pk_bf16_f32 v167, v118, v119
    v_mfma_f32_32x32x16_bf16 v[84:99], v[44:47], v[60:63], v[84:99]
    v_exp_f32 v120, v120
    v_exp_f32 v121, v121
    v_exp_f32 v122, v122
    v_exp_f32 v123, v123
    v_cvt_pk_bf16_f32 v168, v120, v121
    v_cvt_pk_bf16_f32 v169, v122, v123
    v_mfma_f32_32x32x16_bf16 v[84:99], v[48:51], v[64:67], v[84:99]
    buffer_load_dwordx4 v6, s[12:15], s34 offen sc1 lds
    s_add_u32 m0, m0, 8192
    s_add_u32 s34, s34, 8192
    v_exp_f32 v124, v124
    v_exp_f32 v125, v125
    v_exp_f32 v126, v126
    v_exp_f32 v127, v127
    v_cvt_pk_bf16_f32 v170, v124, v125
    v_cvt_pk_bf16_f32 v171, v126, v127
    s_waitcnt lgkmcnt(0)
    v_mfma_f32_32x32x8_bf16 v[112:127], v[38:39], v[32:33], 0
    ds_read2st64_b64 v[160:163], v11 offset0:70 offset1:71
    s_mov_b64 exec, s[26:27]
    ds_read_b64 v[40:41], v11 offset:36864
    s_mov_b64 exec, s[24:25]
    ds_read_b128 v[44:47], v12 offset:30720
    ds_read_b128 v[48:51], v12 offset:31360
    s_mov_b64 exec, -1
    v_exp_f32 v128, v128
    v_exp_f32 v129, v129
    v_exp_f32 v130, v130
    v_exp_f32 v131, v131
    v_cvt_pk_bf16_f32 v60, v128, v129
    v_cvt_pk_bf16_f32 v61, v130, v131
    v_mfma_f32_32x32x16_bf16 v[112:127], v[156:159], v[144:147], v[112:127]
    v_exp_f32 v132, v132
    v_exp_f32 v133, v133
    v_exp_f32 v134, v134
    v_exp_f32 v135, v135
    v_cvt_pk_bf16_f32 v62, v132, v133
    v_cvt_pk_bf16_f32 v63, v134, v135
    v_mfma_f32_32x32x16_bf16 v[68:83], v[52:55], v[164:167], v[68:83]
    v_exp_f32 v136, v136
    v_exp_f32 v137, v137
    v_exp_f32 v138, v138
    v_exp_f32 v139, v139
    v_cvt_pk_bf16_f32 v64, v136, v137
    v_cvt_pk_bf16_f32 v65, v138, v139
    v_mfma_f32_32x32x16_bf16 v[68:83], v[56:59], v[168:171], v[68:83]
    v_exp_f32 v140, v140
    v_exp_f32 v141, v141
    v_exp_f32 v142, v142
    v_exp_f32 v143, v143
    v_cvt_pk_bf16_f32 v66, v140, v141
    v_cvt_pk_bf16_f32 v67, v142, v143
    v_mfma_f32_32x32x8_bf16 v[128:143], v[38:39], v[34:35], 0
    s_setprio 1
    v_exp_f32 v112, v112
    v_exp_f32 v113, v113
    v_exp_f32 v114, v114
    v_exp_f32 v115, v115
    v_cvt_pk_bf16_f32 v164, v112, v113
    v_cvt_pk_bf16_f32 v165, v114, v115
    v_mfma_f32_32x32x16_bf16 v[128:143], v[156:159], v[148:151], v[128:143]
    v_exp_f32 v116, v116
    v_exp_f32 v117, v117
    v_exp_f32 v118, v118
    v_exp_f32 v119, v119
    v_cvt_pk_bf16_f32 v166, v116, v117
    v_cvt_pk_bf16_f32 v167, v118, v119
    v_mfma_f32_32x32x16_bf16 v[84:99], v[52:55], v[60:63], v[84:99]
    v_exp_f32 v120, v120
    v_exp_f32 v121, v121
    v_exp_f32 v122, v122
    v_exp_f32 v123, v123
    v_cvt_pk_bf16_f32 v168, v120, v121
    v_cvt_pk_bf16_f32 v169, v122, v123
    v_mfma_f32_32x32x16_bf16 v[84:99], v[56:59], v[64:67], v[84:99]
    v_exp_f32 v124, v124
    v_exp_f32 v125, v125
    v_exp_f32 v126, v126
    v_exp_f32 v127, v127
    v_cvt_pk_bf16_f32 v170, v124, v125
    v_cvt_pk_bf16_f32 v171, v126, v127
    s_waitcnt lgkmcnt(0)
    v_mfma_f32_32x32x8_bf16 v[112:127], v[40:41], v[32:33], 0
    s_mov_b64 exec, s[24:25]
    ds_read_b128 v[52:55], v12 offset:35840
    ds_read_b128 v[56:59], v12 offset:36480
    s_mov_b64 exec, -1
    v_exp_f32 v128, v128
    v_exp_f32 v129, v129
    v_exp_f32 v130, v130
    v_exp_f32 v131, v131
    v_cvt_pk_bf16_f32 v60, v128, v129
    v_cvt_pk_bf16_f32 v61, v130, v131
    v_mfma_f32_32x32x16_bf16 v[112:127], v[160:163], v[144:147], v[112:127]
    v_exp_f32 v132, v132
    v_exp_f32 v133, v133
    v_exp_f32 v134, v134
    v_exp_f32 v135, v135
    v_cvt_pk_bf16_f32 v62, v132, v133
    v_cvt_pk_bf16_f32 v63, v134, v135
    v_mfma_f32_32x32x16_bf16 v[68:83], v[44:47], v[164:167], v[68:83]
    v_mov_b32 v2, 40960
    ds_read_b32 v4, v2
    v_exp_f32 v136, v136
    v_exp_f32 v137, v137
    v_exp_f32 v138, v138
    v_exp_f32 v139, v139
    v_cvt_pk_bf16_f32 v64, v136, v137
    v_cvt_pk_bf16_f32 v65, v138, v139
    v_mfma_f32_32x32x16_bf16 v[68:83], v[48:51], v[168:171], v[68:83]
    v_exp_f32 v140, v140
    v_exp_f32 v141, v141
    v_exp_f32 v142, v142
    v_exp_f32 v143, v143
    v_cvt_pk_bf16_f32 v66, v140, v141
    v_cvt_pk_bf16_f32 v67, v142, v143
    v_mfma_f32_32x32x8_bf16 v[128:143], v[40:41], v[34:35], 0
    s_setprio 0
    v_exp_f32 v112, v112
    v_exp_f32 v113, v113
    v_exp_f32 v114, v114
    v_exp_f32 v115, v115
    v_cvt_pk_bf16_f32 v164, v112, v113
    v_cvt_pk_bf16_f32 v165, v114, v115
    v_mfma_f32_32x32x16_bf16 v[128:143], v[160:163], v[148:151], v[128:143]
    v_exp_f32 v116, v116
    v_exp_f32 v117, v117
    v_exp_f32 v118, v118
    v_exp_f32 v119, v119
    v_cvt_pk_bf16_f32 v166, v116, v117
    v_cvt_pk_bf16_f32 v167, v118, v119
    v_mfma_f32_32x32x16_bf16 v[84:99], v[44:47], v[60:63], v[84:99]
    v_exp_f32 v120, v120
    v_exp_f32 v121, v121
    v_exp_f32 v122, v122
    v_exp_f32 v123, v123
    v_cvt_pk_bf16_f32 v168, v120, v121
    v_cvt_pk_bf16_f32 v169, v122, v123
    v_mfma_f32_32x32x16_bf16 v[84:99], v[48:51], v[64:67], v[84:99]
    v_exp_f32 v124, v124
    v_exp_f32 v125, v125
    v_exp_f32 v126, v126
    v_exp_f32 v127, v127
    v_cvt_pk_bf16_f32 v170, v124, v125
    v_cvt_pk_bf16_f32 v171, v126, v127
    s_waitcnt lgkmcnt(0)
    v_exp_f32 v128, v128
    v_exp_f32 v129, v129
    v_exp_f32 v130, v130
    v_exp_f32 v131, v131
    v_cvt_pk_bf16_f32 v60, v128, v129
    v_cvt_pk_bf16_f32 v61, v130, v131
    v_readfirstlane_b32 s43, v4
    s_add_u32 s43, s43, 7
    s_and_b32 s43, s43, 7
    v_exp_f32 v132, v132
    v_exp_f32 v133, v133
    v_exp_f32 v134, v134
    v_exp_f32 v135, v135
    v_cvt_pk_bf16_f32 v62, v132, v133
    v_cvt_pk_bf16_f32 v63, v134, v135
    v_mfma_f32_32x32x16_bf16 v[68:83], v[52:55], v[164:167], v[68:83]
    v_exp_f32 v136, v136
    v_exp_f32 v137, v137
    v_exp_f32 v138, v138
    v_exp_f32 v139, v139
    v_cvt_pk_bf16_f32 v64, v136, v137
    v_cvt_pk_bf16_f32 v65, v138, v139
    v_mfma_f32_32x32x16_bf16 v[68:83], v[56:59], v[168:171], v[68:83]
    v_exp_f32 v140, v140
    v_exp_f32 v141, v141
    v_exp_f32 v142, v142
    v_exp_f32 v143, v143
    v_cvt_pk_bf16_f32 v66, v140, v141
    v_cvt_pk_bf16_f32 v67, v142, v143
    s_waitcnt vmcnt(0)
    s_barrier
    s_setprio 3
    v_mfma_f32_32x32x16_bf16 v[84:99], v[52:55], v[60:63], v[84:99]
    v_mfma_f32_32x32x16_bf16 v[84:99], v[56:59], v[64:67], v[84:99]
    s_waitcnt lgkmcnt(0)
    v_add_u32 v11, s79, v8
    v_add_u32 v12, s79, v10
    ds_read2st64_b64 v[160:163], v11 offset0:40 offset1:41
    s_mov_b64 exec, s[26:27]
    ds_read_b64 v[40:41], v11 offset:21504
    s_mov_b64 exec, -1
    ds_read2st64_b64 v[156:159], v11 offset0:45 offset1:46
    s_mov_b64 exec, s[26:27]
    ds_read_b64 v[38:39], v11 offset:24064
    s_mov_b64 exec, s[24:25]
    ds_read_b128 v[44:47], v12 offset:23040
    ds_read_b128 v[48:51], v12 offset:23680
    s_mov_b64 exec, -1
    v_pk_mov_b32 v[216:217], 0, 0
    v_pk_mov_b32 v[218:219], 0, 0
    v_pk_mov_b32 v[220:221], 0, 0
    v_pk_mov_b32 v[222:223], 0, 0
    v_pk_mov_b32 v[224:225], 0, 0
    v_pk_mov_b32 v[226:227], 0, 0
    v_pk_mov_b32 v[228:229], 0, 0
    v_pk_mov_b32 v[230:231], 0, 0
    s_waitcnt lgkmcnt(4)
    s_cmp_eq_u32 s74, 0
    s_cbranch_scc1 L_t0_33
    v_mfma_f32_32x32x8_bf16 v[128:143], v[40:41], v[36:37], 0
    v_mfma_f32_32x32x16_bf16 v[128:143], v[160:163], v[152:155], v[128:143]
    s_nop 11
L_t0b_34:
    v_max3_f32 v15, v128, v129, v130
    v_max3_f32 v15, v15, v131, v132
    v_max3_f32 v15, v15, v133, v134
    v_max3_f32 v15, v15, v135, v136
    v_max3_f32 v15, v15, v137, v138
    v_max3_f32 v15, v15, v139, v140
    v_max3_f32 v15, v15, v141, v142
    v_max_f32 v15, v15, v143
    v_mov_b32 v5, v15
    s_nop 1
    v_permlane32_swap_b32 v5, v15
    s_nop 1
    v_max_f32 v15, v15, v5
    v_sub_f32 v2, 0, v15
    v_and_b32 v3, s23, v2
    v_sub_f32 v2, v2, v3
    v_and_b32 v4, s23, v2
    v_sub_f32 v2, v2, v4
    v_lshrrev_b32 v3, 16, v3
    s_mov_b64 exec, s[100:101]
    v_or_b32 v36, v3, v4
    v_lshrrev_b32 v37, 16, v2
    s_mov_b64 exec, -1
    s_waitcnt lgkmcnt(0)
    v_mfma_f32_32x32x8_bf16 v[112:127], v[38:39], v[36:37], 0
    v_mfma_f32_32x32x16_bf16 v[112:127], v[156:159], v[152:155], v[112:127]
    s_nop 9
    s_mov_b32 exec_lo, 0x0
    s_mov_b32 exec_hi, 0xf
    v_mov_b32 v112, s19
    s_mov_b32 exec_lo, 0x1
    s_mov_b32 exec_hi, 0x1f
    v_mov_b32 v113, s19
    s_mov_b32 exec_lo, 0x3
    s_mov_b32 exec_hi, 0x3f
    v_mov_b32 v114, s19
    s_mov_b32 exec_lo, 0x7
    s_mov_b32 exec_hi, 0x7f
    v_mov_b32 v115, s19
    s_mov_b32 exec_lo, 0xff
    s_mov_b32 exec_hi, 0xfff
    v_mov_b32 v116, s19
    s_mov_b32 exec_lo, 0x1ff
    s_mov_b32 exec_hi, 0x1fff
    v_mov_b32 v117, s19
    s_mov_b32 exec_lo, 0x3ff
    s_mov_b32 exec_hi, 0x3fff
    v_mov_b32 v118, s19
    s_mov_b32 exec_lo, 0x7ff
    s_mov_b32 exec_hi, 0x7fff
    v_mov_b32 v119, s19
    s_mov_b32 exec_lo, 0xffff
    s_mov_b32 exec_hi, 0xfffff
    v_mov_b32 v120, s19
    s_mov_b32 exec_lo, 0x1ffff
    s_mov_b32 exec_hi, 0x1fffff
    v_mov_b32 v121, s19
    s_mov_b32 exec_lo, 0x3ffff
    s_mov_b32 exec_hi, 0x3fffff
    v_mov_b32 v122, s19
    s_mov_b32 exec_lo, 0x7ffff
    s_mov_b32 exec_hi, 0x7fffff
    v_mov_b32 v123, s19
    s_mov_b32 exec_lo, 0xffffff
    s_mov_b32 exec_hi, 0xfffffff
    v_mov_b32 v124, s19
    s_mov_b32 exec_lo, 0x1ffffff
    s_mov_b32 exec_hi, 0x1fffffff
    v_mov_b32 v125, s19
    s_mov_b32 exec_lo, 0x3ffffff
    s_mov_b32 exec_hi, 0x3fffffff
    v_mov_b32 v126, s19
    s_mov_b32 exec_lo, 0x7ffffff
    s_mov_b32 exec_hi, 0x7fffffff
    v_mov_b32 v127, s19
    s_mov_b64 exec, -1
L_at_35:
    v_mfma_f32_32x32x8_bf16 v[128:143], v[40:41], v[36:37], 0
    ds_read2st64_b64 v[156:159], v11 offset0:35 offset1:36
    s_mov_b64 exec, s[26:27]
    ds_read_b64 v[38:39], v11 offset:18944
    s_mov_b64 exec, -1
    v_exp_f32 v112, v112
    v_exp_f32 v113, v113
    v_exp_f32 v114, v114
    v_exp_f32 v115, v115
    v_cvt_pk_bf16_f32 v164, v112, v113
    v_cvt_pk_bf16_f32 v165, v114, v115
    v_exp_f32 v116, v116
    v_exp_f32 v117, v117
    v_exp_f32 v118, v118
    v_exp_f32 v119, v119
    v_cvt_pk_bf16_f32 v166, v116, v117
    v_cvt_pk_bf16_f32 v167, v118, v119
    v_mfma_f32_32x32x16_bf16 v[128:143], v[160:163], v[152:155], v[128:143]
    v_exp_f32 v120, v120
    v_exp_f32 v121, v121
    v_exp_f32 v122, v122
    v_exp_f32 v123, v123
    v_cvt_pk_bf16_f32 v168, v120, v121
    v_cvt_pk_bf16_f32 v169, v122, v123
    s_mov_b64 exec, s[24:25]
    ds_read_b128 v[52:55], v12 offset:20480
    ds_read_b128 v[56:59], v12 offset:21120
    s_mov_b64 exec, -1
    v_exp_f32 v124, v124
    v_exp_f32 v125, v125
    v_exp_f32 v126, v126
    v_exp_f32 v127, v127
    v_cvt_pk_bf16_f32 v170, v124, v125
    v_cvt_pk_bf16_f32 v171, v126, v127
L_at_36:
    s_cmp_lt_u32 s74, 1
    s_cbranch_scc1 L_ma_45
    s_waitcnt lgkmcnt(2)
    v_mfma_f32_32x32x8_bf16 v[112:127], v[38:39], v[36:37], 0
    ds_read2st64_b64 v[160:163], v11 offset0:30 offset1:31
    s_mov_b64 exec, s[26:27]
    ds_read_b64 v[40:41], v11 offset:16384
    s_mov_b64 exec, -1
    v_exp_f32 v128, v128
    v_exp_f32 v129, v129
    v_exp_f32 v130, v130
    v_exp_f32 v131, v131
    v_cvt_pk_bf16_f32 v60, v128, v129
    v_cvt_pk_bf16_f32 v61, v130, v131
    v_mfma_f32_32x32x16_bf16 v[112:127], v[156:159], v[152:155], v[112:127]
    v_exp_f32 v132, v132
    v_exp_f32 v133, v133
    v_exp_f32 v134, v134
    v_exp_f32 v135, v135
    v_cvt_pk_bf16_f32 v62, v132, v133
    v_cvt_pk_bf16_f32 v63, v134, v135
    v_mfma_f32_32x32x16_bf16 v[216:231], v[44:47], v[164:167], v[216:231]
    v_exp_f32 v136, v136
    v_exp_f32 v137, v137
    v_exp_f32 v138, v138
    v_exp_f32 v139, v139
    v_cvt_pk_bf16_f32 v64, v136, v137
    v_cvt_pk_bf16_f32 v65, v138, v139
    v_mfma_f32_32x32x16_bf16 v[216:231], v[48:51], v[168:171], v[216:231]
    s_mov_b64 exec, s[24:25]
    ds_read_b128 v[44:47], v12 offset:17920
    ds_read_b128 v[48:51], v12 offset:18560
    s_mov_b64 exec, -1
    v_exp_f32 v140, v140
    v_exp_f32 v141, v141
    v_exp_f32 v142, v142
    v_exp_f32 v143, v143
    v_cvt_pk_bf16_f32 v66, v140, v141
    v_cvt_pk_bf16_f32 v67, v142, v143
L_at_37:
    s_cmp_lt_u32 s74, 2
    s_cbranch_scc1 L_ma_46
    s_waitcnt lgkmcnt(2)
    v_mfma_f32_32x32x8_bf16 v[128:143], v[40:41], v[36:37], 0
    ds_read2st64_b64 v[156:159], v11 offset0:25 offset1:26
    s_mov_b64 exec, s[26:27]
    ds_read_b64 v[38:39], v11 offset:13824
    s_mov_b64 exec, -1
    v_exp_f32 v112, v112
    v_exp_f32 v113, v113
    v_exp_f32 v114, v114
    v_exp_f32 v115, v115
    v_cvt_pk_bf16_f32 v164, v112, v113
    v_cvt_pk_bf16_f32 v165, v114, v115
    v_mfma_f32_32x32x16_bf16 v[128:143], v[160:163], v[152:155], v[128:143]
    v_exp_f32 v116, v116
    v_exp_f32 v117, v117
    v_exp_f32 v118, v118
    v_exp_f32 v119, v119
    v_cvt_pk_bf16_f32 v166, v116, v117
    v_cvt_pk_bf16_f32 v167, v118, v119
    v_mfma_f32_32x32x16_bf16 v[216:231], v[52:55], v[60:63], v[216:231]
    v_exp_f32 v120, v120
    v_exp_f32 v121, v121
    v_exp_f32 v122, v122
    v_exp_f32 v123, v123
    v_cvt_pk_bf16_f32 v168, v120, v121
    v_cvt_pk_bf16_f32 v169, v122, v123
    v_mfma_f32_32x32x16_bf16 v[216:231], v[56:59], v[64:67], v[216:231]
    s_mov_b64 exec, s[24:25]
    ds_read_b128 v[52:55], v12 offset:15360
    ds_read_b128 v[56:59], v12 offset:16000
    s_mov_b64 exec, -1
    v_exp_f32 v124, v124
    v_exp_f32 v125, v125
    v_exp_f32 v126, v126
    v_exp_f32 v127, v127
    v_cvt_pk_bf16_f32 v170, v124, v125
    v_cvt_pk_bf16_f32 v171, v126, v127
L_at_38:
    s_cmp_lt_u32 s74, 3
    s_cbranch_scc1 L_ma_47
    s_waitcnt lgkmcnt(2)
    v_mfma_f32_32x32x8_bf16 v[112:127], v[38:39], v[36:37], 0
    ds_read2st64_b64 v[160:163], v11 offset0:20 offset1:21
    s_mov_b64 exec, s[26:27]
    ds_read_b64 v[40:41], v11 offset:11264
    s_mov_b64 exec, -1
    v_exp_f32 v128, v128
    v_exp_f32 v129, v129
    v_exp_f32 v130, v130
    v_exp_f32 v131, v131
    v_cvt_pk_bf16_f32 v60, v128, v129
    v_cvt_pk_bf16_f32 v61, v130, v131
    v_mfma_f32_32x32x16_bf16 v[112:127], v[156:159], v[152:155], v[112:127]
    v_exp_f32 v132, v132
    v_exp_f32 v133, v133
    v_exp_f32 v134, v134
    v_exp_f32 v135, v135
    v_cvt_pk_bf16_f32 v62, v132, v133
    v_cvt_pk_bf16_f32 v63, v134, v135
    v_mfma_f32_32x32x16_bf16 v[216:231], v[44:47], v[164:167], v[216:231]
    v_exp_f32 v136, v136
    v_exp_f32 v137, v137
    v_exp_f32 v138, v138
    v_exp_f32 v139, v139
    v_cvt_pk_bf16_f32 v64, v136, v137
    v_cvt_pk_bf16_f32 v65, v138, v139
    v_mfma_f32_32x32x16_bf16 v[216:231], v[48:51], v[168:171], v[216:231]
    s_mov_b64 exec, s[24:25]
    ds_read_b128 v[44:47], v12 offset:12800
    ds_read_b128 v[48:51], v12 offset:13440
    s_mov_b64 exec, -1
    v_exp_f32 v140, v140
    v_exp_f32 v141, v141
    v_exp_f32 v142, v142
    v_exp_f32 v143, v143
    v_cvt_pk_bf16_f32 v66, v140, v141
    v_cvt_pk_bf16_f32 v67, v142, v143
L_at_39:
    s_cmp_lt_u32 s74, 4
    s_cbranch_scc1 L_ma_48
    s_waitcnt lgkmcnt(2)
    v_mfma_f32_32x32x8_bf16 v[128:143], v[40:41], v[36:37], 0
    ds_read2st64_b64 v[156:159], v11 offset0:15 offset1:16
    s_mov_b64 exec, s[26:27]
    ds_read_b64 v[38:39], v11 offset:8704
    s_mov_b64 exec, -1
    v_exp_f32 v112, v112
    v_exp_f32 v113, v113
    v_exp_f32 v114, v114
    v_exp_f32 v115, v115
    v_cvt_pk_bf16_f32 v164, v112, v113
    v_cvt_pk_bf16_f32 v165, v114, v115
    v_mfma_f32_32x32x16_bf16 v[128:143], v[160:163], v[152:155], v[128:143]
    v_exp_f32 v116, v116
    v_exp_f32 v117, v117
    v_exp_f32 v118, v118
    v_exp_f32 v119, v119
    v_cvt_pk_bf16_f32 v166, v116, v117
    v_cvt_pk_bf16_f32 v167, v118, v119
    v_mfma_f32_32x32x16_bf16 v[216:231], v[52:55], v[60:63], v[216:231]
    v_exp_f32 v120, v120
    v_exp_f32 v121, v121
    v_exp_f32 v122, v122
    v_exp_f32 v123, v123
    v_cvt_pk_bf16_f32 v168, v120, v121
    v_cvt_pk_bf16_f32 v169, v122, v123
    v_mfma_f32_32x32x16_bf16 v[216:231], v[56:59], v[64:67], v[216:231]
    s_mov_b64 exec, s[24:25]
    ds_read_b128 v[52:55], v12 offset:10240
    ds_read_b128 v[56:59], v12 offset:10880
    s_mov_b64 exec, -1
    v_exp_f32 v124, v124
    v_exp_f32 v125, v125
    v_exp_f32 v126, v126
    v_exp_f32 v127, v127
    v_cvt_pk_bf16_f32 v170, v124, v125
    v_cvt_pk_bf16_f32 v171, v126, v127
L_at_40:
    s_cmp_lt_u32 s74, 5
    s_cbranch_scc1 L_ma_49
    s_waitcnt lgkmcnt(2)
    v_mfma_f32_32x32x8_bf16 v[112:127], v[38:39], v[36:37], 0
    ds_read2st64_b64 v[160:163], v11 offset0:10 offset1:11
    s_mov_b64 exec, s[26:27]
    ds_read_b64 v[40:41], v11 offset:6144
    s_mov_b64 exec, -1
    v_exp_f32 v128, v128
    v_exp_f32 v129, v129
    v_exp_f32 v130, v130
    v_exp_f32 v131, v131
    v_cvt_pk_bf16_f32 v60, v128, v129
    v_cvt_pk_bf16_f32 v61, v130, v131
    v_mfma_f32_32x32x16_bf16 v[112:127], v[156:159], v[152:155], v[112:127]
    v_exp_f32 v132, v132
    v_exp_f32 v133, v133
    v_exp_f32 v134, v134
    v_exp_f32 v135, v135
    v_cvt_pk_bf16_f32 v62, v132, v133
    v_cvt_pk_bf16_f32 v63, v134, v135
    v_mfma_f32_32x32x16_bf16 v[216:231], v[44:47], v[164:167], v[216:231]
    v_exp_f32 v136, v136
    v_exp_f32 v137, v137
    v_exp_f32 v138, v138
    v_exp_f32 v139, v139
    v_cvt_pk_bf16_f32 v64, v136, v137
    v_cvt_pk_bf16_f32 v65, v138, v139
    v_mfma_f32_32x32x16_bf16 v[216:231], v[48:51], v[168:171], v[216:231]
    s_mov_b64 exec, s[24:25]
    ds_read_b128 v[44:47], v12 offset:7680
    ds_read_b128 v[48:51], v12 offset:8320
    s_mov_b64 exec, -1
    v_exp_f32 v140, v140
    v_exp_f32 v141, v141
    v_exp_f32 v142, v142
    v_exp_f32 v143, v143
    v_cvt_pk_bf16_f32 v66, v140, v141
    v_cvt_pk_bf16_f32 v67, v142, v143
L_at_41:
    s_cmp_lt_u32 s74, 6
    s_cbranch_scc1 L_ma_50
    s_waitcnt lgkmcnt(2)
    v_mfma_f32_32x32x8_bf16 v[128:143], v[40:41], v[36:37], 0
    ds_read2st64_b64 v[156:159], v11 offset0:5 offset1:6
    s_mov_b64 exec, s[26:27]
    ds_read_b64 v[38:39], v11 offset:3584
    s_mov_b64 exec, -1
    v_exp_f32 v112, v112
    v_exp_f32 v113, v113
    v_exp_f32 v114, v114
    v_exp_f32 v115, v115
    v_cvt_pk_bf16_f32 v164, v112, v113
    v_cvt_pk_bf16_f32 v165, v114, v115
    v_mfma_f32_32x32x16_bf16 v[128:143], v[160:163], v[152:155], v[128:143]
    v_exp_f32 v116, v116
    v_exp_f32 v117, v117
    v_exp_f32 v118, v118
    v_exp_f32 v119, v119
    v_cvt_pk_bf16_f32 v166, v116, v117
    v_cvt_pk_bf16_f32 v167, v118, v119
    v_mfma_f32_32x32x16_bf16 v[216:231], v[52:55], v[60:63], v[216:231]
    v_exp_f32 v120, v120
    v_exp_f32 v121, v121
    v_exp_f32 v122, v122
    v_exp_f32 v123, v123
    v_cvt_pk_bf16_f32 v168, v120, v121
    v_cvt_pk_bf16_f32 v169, v122, v123
    v_mfma_f32_32x32x16_bf16 v[216:231], v[56:59], v[64:67], v[216:231]
    s_mov_b64 exec, s[24:25]
    ds_read_b128 v[52:55], v12 offset:5120
    ds_read_b128 v[56:59], v12 offset:5760
    s_mov_b64 exec, -1
    v_exp_f32 v124, v124
    v_exp_f32 v125, v125
    v_exp_f32 v126, v126
    v_exp_f32 v127, v127
    v_cvt_pk_bf16_f32 v170, v124, v125
    v_cvt_pk_bf16_f32 v171, v126, v127
L_at_42:
    s_cmp_lt_u32 s74, 7
    s_cbranch_scc1 L_ma_51
    s_waitcnt lgkmcnt(2)
    v_mfma_f32_32x32x8_bf16 v[112:127], v[38:39], v[36:37], 0
    v_exp_f32 v128, v128
    v_exp_f32 v129, v129
    v_exp_f32 v130, v130
    v_exp_f32 v131, v131
    v_cvt_pk_bf16_f32 v60, v128, v129
    v_cvt_pk_bf16_f32 v61, v130, v131
    v_mfma_f32_32x32x16_bf16 v[112:127], v[156:159], v[152:155], v[112:127]
    v_exp_f32 v132, v132
    v_exp_f32 v133, v133
    v_exp_f32 v134, v134
    v_exp_f32 v135, v135
    v_cvt_pk_bf16_f32 v62, v132, v133
    v_cvt_pk_bf16_f32 v63, v134, v135
    v_mfma_f32_32x32x16_bf16 v[216:231], v[44:47], v[164:167], v[216:231]
    v_exp_f32 v136, v136
    v_exp_f32 v137, v137
    v_exp_f32 v138, v138
    v_exp_f32 v139, v139
    v_cvt_pk_bf16_f32 v64, v136, v137
    v_cvt_pk_bf16_f32 v65, v138, v139
    v_mfma_f32_32x32x16_bf16 v[216:231], v[48:51], v[168:171], v[216:231]
    s_mov_b64 exec, s[24:25]
    ds_read_b128 v[44:47], v12 offset:2560
    ds_read_b128 v[48:51], v12 offset:3200
    s_mov_b64 exec, -1
    v_exp_f32 v140, v140
    v_exp_f32 v141, v141
    v_exp_f32 v142, v142
    v_exp_f32 v143, v143
    v_cvt_pk_bf16_f32 v66, v140, v141
    v_cvt_pk_bf16_f32 v67, v142, v143
L_at_43:
    s_cmp_lt_u32 s74, 8
    s_cbranch_scc1 L_ma_52
    s_mov_b32 exec_lo, 0xffffffff
    s_mov_b32 exec_hi, 0xfffffff0
    v_mov_b32 v112, s19
    s_mov_b32 exec_lo, 0xfffffffe
    s_mov_b32 exec_hi, 0xffffffe0
    v_mov_b32 v113, s19
    s_mov_b32 exec_lo, 0xfffffffc
    s_mov_b32 exec_hi, 0xffffffc0
    v_mov_b32 v114, s19
    s_mov_b32 exec_lo, 0xfffffff8
    s_mov_b32 exec_hi, 0xffffff80
    v_mov_b32 v115, s19
    s_mov_b32 exec_lo, 0xffffff00
    s_mov_b32 exec_hi, 0xfffff000
    v_mov_b32 v116, s19
    s_mov_b32 exec_lo, 0xfffffe00
    s_mov_b32 exec_hi, 0xffffe000
    v_mov_b32 v117, s19
    s_mov_b32 exec_lo, 0xfffffc00
    s_mov_b32 exec_hi, 0xffffc000
    v_mov_b32 v118, s19
    s_mov_b32 exec_lo, 0xfffff800
    s_mov_b32 exec_hi, 0xffff8000
    v_mov_b32 v119, s19
    s_mov_b32 exec_lo, 0xffff0000
    s_mov_b32 exec_hi, 0xfff00000
    v_mov_b32 v120, s19
    s_mov_b32 exec_lo, 0xfffe0000
    s_mov_b32 exec_hi, 0xffe00000
    v_mov_b32 v121, s19
    s_mov_b32 exec_lo, 0xfffc0000
    s_mov_b32 exec_hi, 0xffc00000
    v_mov_b32 v122, s19
    s_mov_b32 exec_lo, 0xfff80000
    s_mov_b32 exec_hi, 0xff800000
    v_mov_b32 v123, s19
    s_mov_b32 exec_lo, 0xff000000
    s_mov_b32 exec_hi, 0xf0000000
    v_mov_b32 v124, s19
    s_mov_b32 exec_lo, 0xfe000000
    s_mov_b32 exec_hi, 0xe0000000
    v_mov_b32 v125, s19
    s_mov_b32 exec_lo, 0xfc000000
    s_mov_b32 exec_hi, 0xc0000000
    v_mov_b32 v126, s19
    s_mov_b32 exec_lo, 0xf8000000
    s_mov_b32 exec_hi, 0x80000000
    v_mov_b32 v127, s19
    s_mov_b64 exec, -1
    s_waitcnt lgkmcnt(2)
    v_mfma_f32_32x32x16_bf16 v[216:231], v[52:55], v[60:63], v[216:231]
    v_exp_f32 v112, v112
    v_exp_f32 v113, v113
    v_exp_f32 v114, v114
    v_exp_f32 v115, v115
    v_cvt_pk_bf16_f32 v164, v112, v113
    v_cvt_pk_bf16_f32 v165, v114, v115
    v_exp_f32 v116, v116
    v_exp_f32 v117, v117
    v_exp_f32 v118, v118
    v_exp_f32 v119, v119
    v_cvt_pk_bf16_f32 v166, v116, v117
    v_cvt_pk_bf16_f32 v167, v118, v119
    v_mfma_f32_32x32x16_bf16 v[216:231], v[56:59], v[64:67], v[216:231]
    v_exp_f32 v120, v120
    v_exp_f32 v121, v121
    v_exp_f32 v122, v122
    v_exp_f32 v123, v123
    v_cvt_pk_bf16_f32 v168, v120, v121
    v_cvt_pk_bf16_f32 v169, v122, v123
    v_exp_f32 v124, v124
    v_exp_f32 v125, v125
    v_exp_f32 v126, v126
    v_exp_f32 v127, v127
    v_cvt_pk_bf16_f32 v170, v124, v125
    v_cvt_pk_bf16_f32 v171, v126, v127
    s_waitcnt lgkmcnt(0)
    s_nop 0
    v_mfma_f32_32x32x16_bf16 v[216:231], v[44:47], v[164:167], v[216:231]
    v_mfma_f32_32x32x16_bf16 v[216:231], v[48:51], v[168:171], v[216:231]
L_at_44:
    s_mul_i32 s44, s72, 2560
    s_add_u32 s44, s44, 81920
    v_add_u32 v11, s44, v8
    v_add_u32 v12, s44, v10
    v_pk_mov_b32 v[60:61], 0, 0
    v_pk_mov_b32 v[62:63], 0, 0
    v_pk_mov_b32 v[64:65], 0, 0
    v_pk_mov_b32 v[66:67], 0, 0
    s_nop 4
    v_add_f32 v2, abs(v216), abs(v217)
    v_add_f32 v3, abs(v218), abs(v219)
    v_add_f32 v2, v2, abs(v220)
    v_add_f32 v3, v3, abs(v221)
    v_add_f32 v2, v2, abs(v222)
    v_add_f32 v3, v3, abs(v223)
    v_add_f32 v2, v2, abs(v224)
    v_add_f32 v3, v3, abs(v225)
    v_add_f32 v2, v2, abs(v226)
    v_add_f32 v3, v3, abs(v227)
    v_add_f32 v2, v2, v3
    s_mov_b32 s44, 0x7b800000
    s_mov_b32 s45, 0x35800000
    s_mov_b32 s46, 0x7f800000
    v_cmp_nlt_f32 s[48:49], v228, s44
    v_cmp_ngt_f32 s[50:51], v228, s45
    v_cmp_nlt_f32 s[52:53], v2, s46
    s_or_b64 s[48:49], s[48:49], s[50:51]
    s_or_b64 s[48:49], s[48:49], s[52:53]
    s_cbranch_scc1 L_slow_53
L_ret_54:
    v_rcp_f32 v2, v228
    ds_read2st64_b64 v[156:159], v11 offset0:0 offset1:1
    s_mov_b64 exec, s[26:27]
    ds_read_b64 v[38:39], v11 offset:1024
    s_mov_b64 exec, s[24:25]
    ds_read_b128 v[44:47], v12 offset:0
    ds_read_b128 v[48:51], v12 offset:640
    s_mov_b64 exec, -1
    ds_read2st64_b64 v[160:163], v11 offset0:10 offset1:11
    s_mov_b64 exec, s[26:27]
    ds_read_b64 v[40:41], v11 offset:6144
    s_mov_b64 exec, -1
    v_mul_f32 v216, v2, v216
    v_mul_f32 v217, v2, v217
    v_mul_f32 v218, v2, v218
    v_mul_f32 v219, v2, v219
    v_mul_f32 v220, v2, v220
    v_mul_f32 v221, v2, v221
    v_mul_f32 v222, v2, v222
    v_mul_f32 v223, v2, v223
    v_mul_f32 v224, v2, v224
    v_mul_f32 v225, v2, v225
    v_mul_f32 v226, v2, v226
    v_mul_f32 v227, v2, v227
    v_cvt_pk_bf16_f32 v216, v216, v217
    v_cvt_pk_bf16_f32 v217, v218, v219
    v_cvt_pk_bf16_f32 v218, v220, v221
    v_cvt_pk_bf16_f32 v219, v222, v223
    v_cvt_pk_bf16_f32 v220, v224, v225
    v_cvt_pk_bf16_f32 v221, v226, v227
    buffer_store_dwordx4 v[216:219], v13, s[12:15], s82 offen sc1
    s_mov_b64 exec, s[26:27]
    buffer_store_dwordx2 v[220:221], v14, s[12:15], s83 offen sc1
    s_mov_b64 exec, -1
    s_waitcnt lgkmcnt(4)
    v_mfma_f32_32x32x8_bf16 v[112:127], v[38:39], v[32:33], 0
    v_mfma_f32_32x32x16_bf16 v[112:127], v[156:159], v[144:147], v[112:127]
    v_mov_b32 v2, 40960
    v_mov_b32 v3, 1
    s_waitcnt vmcnt(0)
    s_mov_b64 exec, 1
    ds_add_rtn_u32 v4, v2, v3
    s_waitcnt lgkmcnt(0)
    v_readfirstlane_b32 s44, v4
    s_and_b32 s44, s44, 7
    s_cmp_lg_u32 s44, s43
    s_cbranch_scc1 L_ns_55
    buffer_atomic_add v3, v28, s[12:15], s84 offen sc1
L_ns_55:
    s_mov_b64 exec, -1
    s_nop 0
.p2align 3
    v_mfma_f32_32x32x8_bf16 v[128:143], v[38:39], v[34:35], 0
    s_setprio 2
    v_exp_f32 v112, v112
    v_exp_f32 v113, v113
    v_exp_f32 v114, v114
    v_exp_f32 v115, v115
    v_cvt_pk_bf16_f32 v164, v112, v113
    v_cvt_pk_bf16_f32 v165, v114, v115
    v_mfma_f32_32x32x16_bf16 v[128:143], v[156:159], v[148:151], v[128:143]
    v_exp_f32 v116, v116
    v_exp_f32 v117, v117
    v_exp_f32 v118, v118
    v_exp_f32 v119, v119
    v_cvt_pk_bf16_f32 v166, v116, v117
    v_cvt_pk_bf16_f32 v167, v118, v119
    v_mfma_f32_32x32x16_bf16 v[84:99], v[52:55], v[60:63], v[84:99]
    v_exp_f32 v120, v120
    v_exp_f32 v121, v121
    v_exp_f32 v122, v122
    v_exp_f32 v123, v123
    v_cvt_pk_bf16_f32 v168, v120, v121
    v_cvt_pk_bf16_f32 v169, v122, v123
    v_mfma_f32_32x32x16_bf16 v[84:99], v[56:59], v[64:67], v[84:99]
    v_exp_f32 v124, v124
    v_exp_f32 v125, v125
    v_exp_f32 v126, v126
    v_exp_f32 v127, v127
    v_cvt_pk_bf16_f32 v170, v124, v125
    v_cvt_pk_bf16_f32 v171, v126, v127
    s_waitcnt lgkmcnt(0)
    v_mfma_f32_32x32x8_bf16 v[112:127], v[40:41], v[32:33], 0
    ds_read2st64_b64 v[156:159], v11 offset0:20 offset1:21
    s_mov_b64 exec, s[26:27]
    ds_read_b64 v[38:39], v11 offset:11264
    s_mov_b64 exec, s[24:25]
    ds_read_b128 v[52:55], v12 offset:5120
    ds_read_b128 v[56:59], v12 offset:5760
    s_mov_b64 exec, -1
    v_exp_f32 v128, v128
    v_exp_f32 v129, v129
    v_exp_f32 v130, v130
    v_exp_f32 v131, v131
    v_cvt_pk_bf16_f32 v60, v128, v129
    v_cvt_pk_bf16_f32 v61, v130, v131
    v_mfma_f32_32x32x16_bf16 v[112:127], v[160:163], v[144:147], v[112:127]
    v_exp_f32 v132, v132
    v_exp_f32 v133, v133
    v_exp_f32 v134, v134
    v_exp_f32 v135, v135
    v_cvt_pk_bf16_f32 v62, v132, v133
    v_cvt_pk_bf16_f32 v63, v134, v135
    v_mfma_f32_32x32x16_bf16 v[68:83], v[44:47], v[164:167], v[68:83]
    v_exp_f32 v136, v136
    v_exp_f32 v137, v137
    v_exp_f32 v138, v138
    v_exp_f32 v139, v139
    v_cvt_pk_bf16_f32 v64, v136, v137
    v_cvt_pk_bf16_f32 v65, v138, v139
    v_mfma_f32_32x32x16_bf16 v[68:83], v[48:51], v[168:171], v[68:83]
    v_exp_f32 v140, v140
    v_exp_f32 v141, v141
    v_exp_f32 v142, v142
    v_exp_f32 v143, v143
    v_cvt_pk_bf16_f32 v66, v140, v141
    v_cvt_pk_bf16_f32 v67, v142, v143
    v_mfma_f32_32x32x8_bf16 v[128:143], v[40:41], v[34:35], 0
    v_exp_f32 v112, v112
    v_exp_f32 v113, v113
    v_exp_f32 v114, v114
    v_exp_f32 v115, v115
    v_cvt_pk_bf16_f32 v164, v112, v113
    v_cvt_pk_bf16_f32 v165, v114, v115
    v_mfma_f32_32x32x16_bf16 v[128:143], v[160:163], v[148:151], v[128:143]
    v_exp_f32 v116, v116
    v_exp_f32 v117, v117
    v_exp_f32 v118, v118
    v_exp_f32 v119, v119
    v_cvt_pk_bf16_f32 v166, v116, v117
    v_cvt_pk_bf16_f32 v167, v118, v119
    v_mfma_f32_32x32x16_bf16 v[84:99], v[44:47], v[60:63], v[84:99]
    v_exp_f32 v120, v120
    v_exp_f32 v121, v121
    v_exp_f32 v122, v122
    v_exp_f32 v123, v123
    v_cvt_pk_bf16_f32 v168, v120, v121
    v_cvt_pk_bf16_f32 v169, v122, v123
    v_mfma_f32_32x32x16_bf16 v[84:99], v[48:51], v[64:67], v[84:99]
    v_exp_f32 v124, v124
    v_exp_f32 v125, v125
    v_exp_f32 v126, v126
    v_exp_f32 v127, v127
    v_cvt_pk_bf16_f32 v170, v124, v125
    v_cvt_pk_bf16_f32 v171, v126, v127
    s_waitcnt lgkmcnt(0)
    v_mfma_f32_32x32x8_bf16 v[112:127], v[38:39], v[32:33], 0
    ds_read2st64_b64 v[160:163], v11 offset0:30 offset1:31
    s_mov_b64 exec, s[26:27]
    ds_read_b64 v[40:41], v11 offset:16384
    s_mov_b64 exec, s[24:25]
    ds_read_b128 v[44:47], v12 offset:10240
    ds_read_b128 v[48:51], v12 offset:10880
    s_mov_b64 exec, -1
    v_exp_f32 v128, v128
    v_exp_f32 v129, v129
    v_exp_f32 v130, v130
    v_exp_f32 v131, v131
    v_cvt_pk_bf16_f32 v60, v128, v129
    v_cvt_pk_bf16_f32 v61, v130, v131
    v_mfma_f32_32x32x16_bf16 v[112:127], v[156:159], v[144:147], v[112:127]
    v_exp_f32 v132, v132
    v_exp_f32 v133, v133
    v_exp_f32 v134, v134
    v_exp_f32 v135, v135
    v_cvt_pk_bf16_f32 v62, v132, v133
    v_cvt_pk_bf16_f32 v63, v134, v135
    v_mfma_f32_32x32x16_bf16 v[68:83], v[52:55], v[164:167], v[68:83]
    v_exp_f32 v136, v136
    v_exp_f32 v137, v137
    v_exp_f32 v138, v138
    v_exp_f32 v139, v139
    v_cvt_pk_bf16_f32 v64, v136, v137
    v_cvt_pk_bf16_f32 v65, v138, v139
    v_mfma_f32_32x32x16_bf16 v[68:83], v[56:59], v[168:171], v[68:83]
    v_exp_f32 v140, v140
    v_exp_f32 v141, v141
    v_exp_f32 v142, v142
    v_exp_f32 v143, v143
    v_cvt_pk_bf16_f32 v66, v140, v141
    v_cvt_pk_bf16_f32 v67, v142, v143
    v_mfma_f32_32x32x8_bf16 v[128:143], v[38:39], v[34:35], 0
    v_exp_f32 v112, v112
    v_exp_f32 v113, v113
    v_exp_f32 v114, v114
    v_exp_f32 v115, v115
    v_cvt_pk_bf16_f32 v164, v112, v113
    v_cvt_pk_bf16_f32 v165, v114, v115
    v_mfma_f32_32x32x16_bf16 v[128:143], v[156:159], v[148:151], v[128:143]
    v_exp_f32 v116, v116
    v_exp_f32 v117, v117
    v_exp_f32 v118, v118
    v_exp_f32 v119, v119
    v_cvt_pk_bf16_f32 v166, v116, v117
    v_cvt_pk_bf16_f32 v167, v118, v119
    v_mfma_f32_32x32x16_bf16 v[84:99], v[52:55], v[60:63], v[84:99]
    v_exp_f32 v120, v120
    v_exp_f32 v121, v121
    v_exp_f32 v122, v122
    v_exp_f32 v123, v123
    v_cvt_pk_bf16_f32 v168, v120, v121
    v_cvt_pk_bf16_f32 v169, v122, v123
    v_mfma_f32_32x32x16_bf16 v[84:99], v[56:59], v[64:67], v[84:99]
    v_exp_f32 v124, v124
    v_exp_f32 v125, v125
    v_exp_f32 v126, v126
    v_exp_f32 v127, v127
    v_cvt_pk_bf16_f32 v170, v124, v125
    v_cvt_pk_bf16_f32 v171, v126, v127
    s_waitcnt lgkmcnt(0)
    v_mfma_f32_32x32x8_bf16 v[112:127], v[40:41], v[32:33], 0
    ds_read2st64_b64 v[156:159], v11 offset0:40 offset1:41
    s_mov_b64 exec, s[26:27]
    ds_read_b64 v[38:39], v11 offset:21504
    s_mov_b64 exec, s[24:25]
    ds_read_b128 v[52:55], v12 offset:15360
    ds_read_b128 v[56:59], v12 offset:16000
    s_mov_b64 exec, -1
    v_exp_f32 v128, v128
    v_exp_f32 v129, v129
    v_exp_f32 v130, v130
    v_exp_f32 v131, v131
    v_cvt_pk_bf16_f32 v60, v128, v129
    v_cvt_pk_bf16_f32 v61, v130, v131
    v_mfma_f32_32x32x16_bf16 v[112:127], v[160:163], v[144:147], v[112:127]
    v_exp_f32 v132, v132
    v_exp_f32 v133, v133
    v_exp_f32 v134, v134
    v_exp_f32 v135, v135
    v_cvt_pk_bf16_f32 v62, v132, v133
    v_cvt_pk_bf16_f32 v63, v134, v135
    v_mfma_f32_32x32x16_bf16 v[68:83], v[44:47], v[164:167], v[68:83]
    v_exp_f32 v136, v136
    v_exp_f32 v137, v137
    v_exp_f32 v138, v138
    v_exp_f32 v139, v139
    v_cvt_pk_bf16_f32 v64, v136, v137
    v_cvt_pk_bf16_f32 v65, v138, v139
    v_mfma_f32_32x32x16_bf16 v[68:83], v[48:51], v[168:171], v[68:83]
    v_exp_f32 v140, v140
    v_exp_f32 v141, v141
    v_exp_f32 v142, v142
    v_exp_f32 v143, v143
    v_cvt_pk_bf16_f32 v66, v140, v141
    v_cvt_pk_bf16_f32 v67, v142, v143
    v_mfma_f32_32x32x8_bf16 v[128:143], v[40:41], v[34:35], 0
    v_exp_f32 v112, v112
    v_exp_f32 v113, v113
    v_exp_f32 v114, v114
    v_exp_f32 v115, v115
    v_cvt_pk_bf16_f32 v164, v112, v113
    v_cvt_pk_bf16_f32 v165, v114, v115
    v_mfma_f32_32x32x16_bf16 v[128:143], v[160:163], v[148:151], v[128:143]
    buffer_load_dword v15, v26, s[12:15], s39 offen sc1
    v_exp_f32 v116, v116
    v_exp_f32 v117, v117
    v_exp_f32 v118, v118
    v_exp_f32 v119, v119
    v_cvt_pk_bf16_f32 v166, v116, v117
    v_cvt_pk_bf16_f32 v167, v118, v119
    v_mfma_f32_32x32x16_bf16 v[84:99], v[44:47], v[60:63], v[84:99]
    v_exp_f32 v120, v120
    v_exp_f32 v121, v121
    v_exp_f32 v122, v122
    v_exp_f32 v123, v123
    v_cvt_pk_bf16_f32 v168, v120, v121
    v_cvt_pk_bf16_f32 v169, v122, v123
    v_mfma_f32_32x32x16_bf16 v[84:99], v[48:51], v[64:67], v[84:99]
    v_exp_f32 v124, v124
    v_exp_f32 v125, v125
    v_exp_f32 v126, v126
    v_exp_f32 v127, v127
    v_cvt_pk_bf16_f32 v170, v124, v125
    v_cvt_pk_bf16_f32 v171, v126, v127
    s_waitcnt lgkmcnt(0)
    v_mfma_f32_32x32x8_bf16 v[112:127], v[38:39], v[32:33], 0
    ds_read2st64_b64 v[160:163], v11 offset0:50 offset1:51
    s_mov_b64 exec, s[26:27]
    ds_read_b64 v[40:41], v11 offset:26624
    s_mov_b64 exec, s[24:25]
    ds_read_b128 v[44:47], v12 offset:20480
    ds_read_b128 v[48:51], v12 offset:21120
    s_mov_b64 exec, -1
    v_exp_f32 v128, v128
    v_exp_f32 v129, v129
    v_exp_f32 v130, v130
    v_exp_f32 v131, v131
    v_cvt_pk_bf16_f32 v60, v128, v129
    v_cvt_pk_bf16_f32 v61, v130, v131
    v_mfma_f32_32x32x16_bf16 v[112:127], v[156:159], v[144:147], v[112:127]
    v_exp_f32 v132, v132
    v_exp_f32 v133, v133
    v_exp_f32 v134, v134
    v_exp_f32 v135, v135
    v_cvt_pk_bf16_f32 v62, v132, v133
    v_cvt_pk_bf16_f32 v63, v134, v135
    v_mfma_f32_32x32x16_bf16 v[68:83], v[52:55], v[164:167], v[68:83]
    v_exp_f32 v136, v136
    v_exp_f32 v137, v137
    v_exp_f32 v138, v138
    v_exp_f32 v139, v139
    v_cvt_pk_bf16_f32 v64, v136, v137
    v_cvt_pk_bf16_f32 v65, v138, v139
    v_mfma_f32_32x32x16_bf16 v[68:83], v[56:59], v[168:171], v[68:83]
    v_exp_f32 v140, v140
    v_exp_f32 v141, v141
    v_exp_f32 v142, v142
    v_exp_f32 v143, v143
    v_cvt_pk_bf16_f32 v66, v140, v141
    v_cvt_pk_bf16_f32 v67, v142, v143
    v_mfma_f32_32x32x8_bf16 v[128:143], v[38:39], v[34:35], 0
    v_exp_f32 v112, v112
    v_exp_f32 v113, v113
    v_exp_f32 v114, v114
    v_exp_f32 v115, v115
    v_cvt_pk_bf16_f32 v164, v112, v113
    v_cvt_pk_bf16_f32 v165, v114, v115
    v_mfma_f32_32x32x16_bf16 v[128:143], v[156:159], v[148:151], v[128:143]
    v_exp_f32 v116, v116
    v_exp_f32 v117, v117
    v_exp_f32 v118, v118
    v_exp_f32 v119, v119
    v_cvt_pk_bf16_f32 v166, v116, v117
    v_cvt_pk_bf16_f32 v167, v118, v119
    v_mfma_f32_32x32x16_bf16 v[84:99], v[52:55], v[60:63], v[84:99]
    v_exp_f32 v120, v120
    v_exp_f32 v121, v121
    v_exp_f32 v122, v122
    v_exp_f32 v123, v123
    v_cvt_pk_bf16_f32 v168, v120, v121
    v_cvt_pk_bf16_f32 v169, v122, v123
    v_mfma_f32_32x32x16_bf16 v[84:99], v[56:59], v[64:67], v[84:99]
    v_exp_f32 v124, v124
    v_exp_f32 v125, v125
    v_exp_f32 v126, v126
    v_exp_f32 v127, v127
    v_cvt_pk_bf16_f32 v170, v124, v125
    v_cvt_pk_bf16_f32 v171, v126, v127
    s_waitcnt lgkmcnt(0)
    v_mfma_f32_32x32x8_bf16 v[112:127], v[40:41], v[32:33], 0
    ds_read2st64_b64 v[156:159], v11 offset0:60 offset1:61
    s_mov_b64 exec, s[26:27]
    ds_read_b64 v[38:39], v11 offset:31744
    s_mov_b64 exec, s[24:25]
    ds_read_b128 v[52:55], v12 offset:25600
    ds_read_b128 v[56:59], v12 offset:26240
    s_mov_b64 exec, -1
    v_exp_f32 v128, v128
    v_exp_f32 v129, v129
    v_exp_f32 v130, v130
    v_exp_f32 v131, v131
    v_cvt_pk_bf16_f32 v60, v128, v129
    v_cvt_pk_bf16_f32 v61, v130, v131
    v_mfma_f32_32x32x16_bf16 v[112:127], v[160:163], v[144:147], v[112:127]
    v_exp_f32 v132, v132
    v_exp_f32 v133, v133
    v_exp_f32 v134, v134
    v_exp_f32 v135, v135
    v_cvt_pk_bf16_f32 v62, v132, v133
    v_cvt_pk_bf16_f32 v63, v134, v135
    v_mfma_f32_32x32x16_bf16 v[68:83], v[44:47], v[164:167], v[68:83]
    v_exp_f32 v136, v136
    v_exp_f32 v137, v137
    v_exp_f32 v138, v138
    v_exp_f32 v139, v139
    v_cvt_pk_bf16_f32 v64, v136, v137
    v_cvt_pk_bf16_f32 v65, v138, v139
    v_mfma_f32_32x32x16_bf16 v[68:83], v[48:51], v[168:171], v[68:83]
    v_exp_f32 v140, v140
    v_exp_f32 v141, v141
    v_exp_f32 v142, v142
    v_exp_f32 v143, v143
    v_cvt_pk_bf16_f32 v66, v140, v141
    v_cvt_pk_bf16_f32 v67, v142, v143
    v_mfma_f32_32x32x8_bf16 v[128:143], v[40:41], v[34:35], 0
    s_setprio 1
    v_exp_f32 v112, v112
    v_exp_f32 v113, v113
    v_exp_f32 v114, v114
    v_exp_f32 v115, v115
    v_cvt_pk_bf16_f32 v164, v112, v113
    v_cvt_pk_bf16_f32 v165, v114, v115
    v_mfma_f32_32x32x16_bf16 v[128:143], v[160:163], v[148:151], v[128:143]
    v_exp_f32 v116, v116
    v_exp_f32 v117, v117
    v_exp_f32 v118, v118
    v_exp_f32 v119, v119
    v_cvt_pk_bf16_f32 v166, v116, v117
    v_cvt_pk_bf16_f32 v167, v118, v119
    v_mfma_f32_32x32x16_bf16 v[84:99], v[44:47], v[60:63], v[84:99]
    v_exp_f32 v120, v120
    v_exp_f32 v121, v121
    v_exp_f32 v122, v122
    v_exp_f32 v123, v123
    v_cvt_pk_bf16_f32 v168, v120, v121
    v_cvt_pk_bf16_f32 v169, v122, v123
    v_mfma_f32_32x32x16_bf16 v[84:99], v[48:51], v[64:67], v[84:99]
    v_exp_f32 v124, v124
    v_exp_f32 v125, v125
    v_exp_f32 v126, v126
    v_exp_f32 v127, v127
    v_cvt_pk_bf16_f32 v170, v124, v125
    v_cvt_pk_bf16_f32 v171, v126, v127
    s_waitcnt lgkmcnt(0)
    v_mfma_f32_32x32x8_bf16 v[112:127], v[38:39], v[32:33], 0
    ds_read2st64_b64 v[160:163], v11 offset0:70 offset1:71
    s_mov_b64 exec, s[26:27]
    ds_read_b64 v[40:41], v11 offset:36864
    s_mov_b64 exec, s[24:25]
    ds_read_b128 v[44:47], v12 offset:30720
    ds_read_b128 v[48:51], v12 offset:31360
    s_mov_b64 exec, -1
    v_exp_f32 v128, v128
    v_exp_f32 v129, v129
    v_exp_f32 v130, v130
    v_exp_f32 v131, v131
    v_cvt_pk_bf16_f32 v60, v128, v129
    v_cvt_pk_bf16_f32 v61, v130, v131
    v_mfma_f32_32x32x16_bf16 v[112:127], v[156:159], v[144:147], v[112:127]
    v_exp_f32 v132, v132
    v_exp_f32 v133, v133
    v_exp_f32 v134, v134
    v_exp_f32 v135, v135
    v_cvt_pk_bf16_f32 v62, v132, v133
    v_cvt_pk_bf16_f32 v63, v134, v135
    v_mfma_f32_32x32x16_bf16 v[68:83], v[52:55], v[164:167], v[68:83]
    v_exp_f32 v136, v136
    v_exp_f32 v137, v137
    v_exp_f32 v138, v138
    v_exp_f32 v139, v139
    v_cvt_pk_bf16_f32 v64, v136, v137
    v_cvt_pk_bf16_f32 v65, v138, v139
    v_mfma_f32_32x32x16_bf16 v[68:83], v[56:59], v[168:171], v[68:83]
    v_exp_f32 v140, v140
    v_exp_f32 v141, v141
    v_exp_f32 v142, v142
    v_exp_f32 v143, v143
    v_cvt_pk_bf16_f32 v66, v140, v141
    v_cvt_pk_bf16_f32 v67, v142, v143
    v_mfma_f32_32x32x8_bf16 v[128:143], v[38:39], v[34:35], 0
    v_exp_f32 v112, v112
    v_exp_f32 v113, v113
    v_exp_f32 v114, v114
    v_exp_f32 v115, v115
    v_cvt_pk_bf16_f32 v164, v112, v113
    v_cvt_pk_bf16_f32 v165, v114, v115
    v_mfma_f32_32x32x16_bf16 v[128:143], v[156:159], v[148:151], v[128:143]
    buffer_load_dword v17, v28, s[12:15], s85 offen sc1
    v_exp_f32 v116, v116
    v_exp_f32 v117, v117
    v_exp_f32 v118, v118
    v_exp_f32 v119, v119
    v_cvt_pk_bf16_f32 v166, v116, v117
    v_cvt_pk_bf16_f32 v167, v118, v119
    v_mfma_f32_32x32x16_bf16 v[84:99], v[52:55], v[60:63], v[84:99]
    v_exp_f32 v120, v120
    v_exp_f32 v121, v121
    v_exp_f32 v122, v122
    v_exp_f32 v123, v123
    v_cvt_pk_bf16_f32 v168, v120, v121
    v_cvt_pk_bf16_f32 v169, v122, v123
    v_mfma_f32_32x32x16_bf16 v[84:99], v[56:59], v[64:67], v[84:99]
    v_exp_f32 v124, v124
    v_exp_f32 v125, v125
    v_exp_f32 v126, v126
    v_exp_f32 v127, v127
    v_cvt_pk_bf16_f32 v170, v124, v125
    v_cvt_pk_bf16_f32 v171, v126, v127
    s_waitcnt lgkmcnt(0)
    v_mfma_f32_32x32x8_bf16 v[112:127], v[40:41], v[32:33], 0
    ds_read2st64_b64 v[156:159], v11 offset0:80 offset1:81
    s_mov_b64 exec, s[26:27]
    ds_read_b64 v[38:39], v11 offset:41984
    s_mov_b64 exec, s[24:25]
    ds_read_b128 v[52:55], v12 offset:35840
    ds_read_b128 v[56:59], v12 offset:36480
    s_mov_b64 exec, -1
    v_exp_f32 v128, v128
    v_exp_f32 v129, v129
    v_exp_f32 v130, v130
    v_exp_f32 v131, v131
    v_cvt_pk_bf16_f32 v60, v128, v129
    v_cvt_pk_bf16_f32 v61, v130, v131
    v_mfma_f32_32x32x16_bf16 v[112:127], v[160:163], v[144:147], v[112:127]
    v_exp_f32 v132, v132
    v_exp_f32 v133, v133
    v_exp_f32 v134, v134
    v_exp_f32 v135, v135
    v_cvt_pk_bf16_f32 v62, v132, v133
    v_cvt_pk_bf16_f32 v63, v134, v135
    v_mfma_f32_32x32x16_bf16 v[68:83], v[44:47], v[164:167], v[68:83]
    v_exp_f32 v136, v136
    v_exp_f32 v137, v137
    v_exp_f32 v138, v138
    v_exp_f32 v139, v139
    v_cvt_pk_bf16_f32 v64, v136, v137
    v_cvt_pk_bf16_f32 v65, v138, v139
    v_mfma_f32_32x32x16_bf16 v[68:83], v[48:51], v[168:171], v[68:83]
    v_exp_f32 v140, v140
    v_exp_f32 v141, v141
    v_exp_f32 v142, v142
    v_exp_f32 v143, v143
    v_cvt_pk_bf16_f32 v66, v140, v141
    v_cvt_pk_bf16_f32 v67, v142, v143
    v_mfma_f32_32x32x8_bf16 v[128:143], v[40:41], v[34:35], 0
    s_setprio 0
    v_exp_f32 v112, v112
    v_exp_f32 v113, v113
    v_exp_f32 v114, v114
    v_exp_f32 v115, v115
    v_cvt_pk_bf16_f32 v164, v112, v113
    v_cvt_pk_bf16_f32 v165, v114, v115
    v_mfma_f32_32x32x16_bf16 v[128:143], v[160:163], v[148:151], v[128:143]
    v_exp_f32 v116, v116
    v_exp_f32 v117, v117
    v_exp_f32 v118, v118
    v_exp_f32 v119, v119
    v_cvt_pk_bf16_f32 v166, v116, v117
    v_cvt_pk_bf16_f32 v167, v118, v119
    v_mfma_f32_32x32x16_bf16 v[84:99], v[44:47], v[60:63], v[84:99]
    v_exp_f32 v120, v120
    v_exp_f32 v121, v121
    v_exp_f32 v122, v122
    v_exp_f32 v123, v123
    v_cvt_pk_bf16_f32 v168, v120, v121
    v_cvt_pk_bf16_f32 v169, v122, v123
    v_mfma_f32_32x32x16_bf16 v[84:99], v[48:51], v[64:67], v[84:99]
    v_exp_f32 v124, v124
    v_exp_f32 v125, v125
    v_exp_f32 v126, v126
    v_exp_f32 v127, v127
    v_cvt_pk_bf16_f32 v170, v124, v125
    v_cvt_pk_bf16_f32 v171, v126, v127
    s_waitcnt lgkmcnt(0)
    v_mfma_f32_32x32x8_bf16 v[112:127], v[38:39], v[32:33], 0
    ds_read2st64_b64 v[160:163], v11 offset0:90 offset1:91
    s_mov_b64 exec, s[26:27]
    ds_read_b64 v[40:41], v11 offset:47104
    s_mov_b64 exec, s[24:25]
    ds_read_b128 v[44:47], v12 offset:40960
    ds_read_b128 v[48:51], v12 offset:41600
    s_mov_b64 exec, -1
    v_exp_f32 v128, v128
    v_exp_f32 v129, v129
    v_exp_f32 v130, v130
    v_exp_f32 v131, v131
    v_cvt_pk_bf16_f32 v60, v128, v129
    v_cvt_pk_bf16_f32 v61, v130, v131
    v_mfma_f32_32x32x16_bf16 v[112:127], v[156:159], v[144:147], v[112:127]
    v_exp_f32 v132, v132
    v_exp_f32 v133, v133
    v_exp_f32 v134, v134
    v_exp_f32 v135, v135
    v_cvt_pk_bf16_f32 v62, v132, v133
    v_cvt_pk_bf16_f32 v63, v134, v135
    v_mfma_f32_32x32x16_bf16 v[68:83], v[52:55], v[164:167], v[68:83]
    v_exp_f32 v136, v136
    v_exp_f32 v137, v137
    v_exp_f32 v138, v138
    v_exp_f32 v139, v139
    v_cvt_pk_bf16_f32 v64, v136, v137
    v_cvt_pk_bf16_f32 v65, v138, v139
    v_mfma_f32_32x32x16_bf16 v[68:83], v[56:59], v[168:171], v[68:83]
    v_exp_f32 v140, v140
    v_exp_f32 v141, v141
    v_exp_f32 v142, v142
    v_exp_f32 v143, v143
    v_cvt_pk_bf16_f32 v66, v140, v141
    v_cvt_pk_bf16_f32 v67, v142, v143
    v_add_u32 v11, 40960, v11
    v_add_u32 v12, 40960, v12
    s_add_u32 m0, s76, 20480
    s_mov_b32 s34, s33
    s_mov_b32 s46, 0
    s_lshl_b32 s44, s72, 13
    s_add_u32 s44, s44, s98
    s_add_u32 s44, s44, s46
    s_add_u32 s48, s44, 4096
    s_lshl_b32 s45, s72, 11
    s_add_u32 s45, s45, s98
    s_add_u32 s45, s45, s46
    s_add_u32 s45, s45, 16384
    s_waitcnt vmcnt(0)
    v_readfirstlane_b32 s47, v17
    s_barrier
    s_cmp_eq_u32 s47, 32
    s_cselect_b64 vcc, -1, 0
.p2align 3
    v_mfma_f32_32x32x8_bf16 v[128:143], v[38:39], v[34:35], 0
    s_setprio 3
    v_exp_f32 v112, v112
    v_exp_f32 v113, v113
    v_exp_f32 v114, v114
    v_exp_f32 v115, v115
    v_cvt_pk_bf16_f32 v164, v112, v113
    v_cvt_pk_bf16_f32 v165, v114, v115
    v_mfma_f32_32x32x16_bf16 v[128:143], v[156:159], v[148:151], v[128:143]
    buffer_load_dwordx4 v6, s[12:15], s34 offen sc1 lds
    s_add_u32 m0, m0, 8192
    s_add_u32 s34, s34, 8192
    v_exp_f32 v116, v116
    v_exp_f32 v117, v117
    v_exp_f32 v118, v118
    v_exp_f32 v119, v119
    v_cvt_pk_bf16_f32 v166, v116, v117
    v_cvt_pk_bf16_f32 v167, v118, v119
    v_mfma_f32_32x32x16_bf16 v[84:99], v[52:55], v[60:63], v[84:99]
    v_exp_f32 v120, v120
    v_exp_f32 v121, v121
    v_exp_f32 v122, v122
    v_exp_f32 v123, v123
    v_cvt_pk_bf16_f32 v168, v120, v121
    v_cvt_pk_bf16_f32 v169, v122, v123
    v_mfma_f32_32x32x16_bf16 v[84:99], v[56:59], v[64:67], v[84:99]
    s_cbranch_vccz L_sk_56
    buffer_load_dwordx4 v[188:191], v6, s[12:15], s44 offen offset:3072 sc1
    buffer_load_dwordx4 v[192:195], v6, s[12:15], s48 offen offset:0 sc1
L_sk_56:
    v_exp_f32 v124, v124
    v_exp_f32 v125, v125
    v_exp_f32 v126, v126
    v_exp_f32 v127, v127
    v_cvt_pk_bf16_f32 v170, v124, v125
    v_cvt_pk_bf16_f32 v171, v126, v127
    s_waitcnt lgkmcnt(0)
    v_mfma_f32_32x32x8_bf16 v[112:127], v[40:41], v[32:33], 0
    ds_read2st64_b64 v[156:159], v11 offset0:20 offset1:21
    s_mov_b64 exec, s[26:27]
    ds_read_b64 v[38:39], v11 offset:11264
    s_mov_b64 exec, s[24:25]
    ds_read_b128 v[52:55], v12 offset:5120
    ds_read_b128 v[56:59], v12 offset:5760
    s_mov_b64 exec, -1
    v_exp_f32 v128, v128
    v_exp_f32 v129, v129
    v_exp_f32 v130, v130
    v_exp_f32 v131, v131
    v_cvt_pk_bf16_f32 v60, v128, v129
    v_cvt_pk_bf16_f32 v61, v130, v131
    v_mfma_f32_32x32x16_bf16 v[112:127], v[160:163], v[144:147], v[112:127]
    buffer_load_dwordx4 v6, s[12:15], s34 offen sc1 lds
    s_add_u32 m0, m0, 8192
    s_add_u32 s34, s34, 8192
    v_exp_f32 v132, v132
    v_exp_f32 v133, v133
    v_exp_f32 v134, v134
    v_exp_f32 v135, v135
    v_cvt_pk_bf16_f32 v62, v132, v133
    v_cvt_pk_bf16_f32 v63, v134, v135
    v_mfma_f32_32x32x16_bf16 v[68:83], v[44:47], v[164:167], v[68:83]
    v_exp_f32 v136, v136
    v_exp_f32 v137, v137
    v_exp_f32 v138, v138
    v_exp_f32 v139, v139
    v_cvt_pk_bf16_f32 v64, v136, v137
    v_cvt_pk_bf16_f32 v65, v138, v139
    v_mfma_f32_32x32x16_bf16 v[68:83], v[48:51], v[168:171], v[68:83]
    v_exp_f32 v140, v140
    v_exp_f32 v141, v141
    v_exp_f32 v142, v142
    v_exp_f32 v143, v143
    v_cvt_pk_bf16_f32 v66, v140, v141
    v_cvt_pk_bf16_f32 v67, v142, v143
    v_mfma_f32_32x32x8_bf16 v[128:143], v[40:41], v[34:35], 0
    v_exp_f32 v112, v112
    v_exp_f32 v113, v113
    v_exp_f32 v114, v114
    v_exp_f32 v115, v115
    v_cvt_pk_bf16_f32 v164, v112, v113
    v_cvt_pk_bf16_f32 v165, v114, v115
    v_mfma_f32_32x32x16_bf16 v[128:143], v[160:163], v[148:151], v[128:143]
    buffer_load_dwordx4 v6, s[12:15], s34 offen sc1 lds
    s_add_u32 m0, m0, 8192
    s_add_u32 s34, s34, 8192
    v_exp_f32 v116, v116
    v_exp_f32 v117, v117
    v_exp_f32 v118, v118
    v_exp_f32 v119, v119
    v_cvt_pk_bf16_f32 v166, v116, v117
    v_cvt_pk_bf16_f32 v167, v118, v119
    v_mfma_f32_32x32x16_bf16 v[84:99], v[44:47], v[60:63], v[84:99]
    v_exp_f32 v120, v120
    v_exp_f32 v121, v121
    v_exp_f32 v122, v122
    v_exp_f32 v123, v123
    v_cvt_pk_bf16_f32 v168, v120, v121
    v_cvt_pk_bf16_f32 v169, v122, v123
    v_mfma_f32_32x32x16_bf16 v[84:99], v[48:51], v[64:67], v[84:99]
    s_cbranch_vccz L_sk_57
    buffer_load_dwordx4 v[196:199], v6, s[12:15], s48 offen offset:1024 sc1
    buffer_load_dwordx4 v[200:203], v6, s[12:15], s48 offen offset:2048 sc1
L_sk_57:
    v_exp_f32 v124, v124
    v_exp_f32 v125, v125
    v_exp_f32 v126, v126
    v_exp_f32 v127, v127
    v_cvt_pk_bf16_f32 v170, v124, v125
    v_cvt_pk_bf16_f32 v171, v126, v127
    s_waitcnt lgkmcnt(0)
    v_mfma_f32_32x32x8_bf16 v[112:127], v[38:39], v[32:33], 0
    ds_read2st64_b64 v[160:163], v11 offset0:30 offset1:31
    s_mov_b64 exec, s[26:27]
    ds_read_b64 v[40:41], v11 offset:16384
    s_mov_b64 exec, s[24:25]
    ds_read_b128 v[44:47], v12 offset:10240
    ds_read_b128 v[48:51], v12 offset:10880
    s_mov_b64 exec, -1
    v_exp_f32 v128, v128
    v_exp_f32 v129, v129
    v_exp_f32 v130, v130
    v_exp_f32 v131, v131
    v_cvt_pk_bf16_f32 v60, v128, v129
    v_cvt_pk_bf16_f32 v61, v130, v131
    v_mfma_f32_32x32x16_bf16 v[112:127], v[156:159], v[144:147], v[112:127]
    buffer_load_dwordx4 v6, s[12:15], s34 offen sc1 lds
    s_add_u32 m0, m0, 8192
    s_add_u32 s34, s34, 8192
    v_exp_f32 v132, v132
    v_exp_f32 v133, v133
    v_exp_f32 v134, v134
    v_exp_f32 v135, v135
    v_cvt_pk_bf16_f32 v62, v132, v133
    v_cvt_pk_bf16_f32 v63, v134, v135
    v_mfma_f32_32x32x16_bf16 v[68:83], v[52:55], v[164:167], v[68:83]
    v_exp_f32 v136, v136
    v_exp_f32 v137, v137
    v_exp_f32 v138, v138
    v_exp_f32 v139, v139
    v_cvt_pk_bf16_f32 v64, v136, v137
    v_cvt_pk_bf16_f32 v65, v138, v139
    v_mfma_f32_32x32x16_bf16 v[68:83], v[56:59], v[168:171], v[68:83]
    v_exp_f32 v140, v140
    v_exp_f32 v141, v141
    v_exp_f32 v142, v142
    v_exp_f32 v143, v143
    v_cvt_pk_bf16_f32 v66, v140, v141
    v_cvt_pk_bf16_f32 v67, v142, v143
    v_mfma_f32_32x32x8_bf16 v[128:143], v[38:39], v[34:35], 0
    v_exp_f32 v112, v112
    v_exp_f32 v113, v113
    v_exp_f32 v114, v114
    v_exp_f32 v115, v115
    v_cvt_pk_bf16_f32 v164, v112, v113
    v_cvt_pk_bf16_f32 v165, v114, v115
    v_mfma_f32_32x32x16_bf16 v[128:143], v[156:159], v[148:151], v[128:143]
    buffer_load_dwordx4 v6, s[12:15], s34 offen sc1 lds
    s_add_u32 m0, m0, 8192
    s_add_u32 s34, s34, 8192
    v_exp_f32 v116, v116
    v_exp_f32 v117, v117
    v_exp_f32 v118, v118
    v_exp_f32 v119, v119
    v_cvt_pk_bf16_f32 v166, v116, v117
    v_cvt_pk_bf16_f32 v167, v118, v119
    v_mfma_f32_32x32x16_bf16 v[84:99], v[52:55], v[60:63], v[84:99]
    v_exp_f32 v120, v120
    v_exp_f32 v121, v121
    v_exp_f32 v122, v122
    v_exp_f32 v123, v123
    v_cvt_pk_bf16_f32 v168, v120, v121
    v_cvt_pk_bf16_f32 v169, v122, v123
    v_mfma_f32_32x32x16_bf16 v[84:99], v[56:59], v[64:67], v[84:99]
    s_cbranch_vccz L_sk_58
    buffer_load_dwordx4 v[204:207], v6, s[12:15], s48 offen offset:3072 sc1
    buffer_load_dwordx2 v[208:209], v30, s[12:15], s45 offen offset:0 sc1
L_sk_58:
    v_exp_f32 v124, v124
    v_exp_f32 v125, v125
    v_exp_f32 v126, v126
    v_exp_f32 v127, v127
    v_cvt_pk_bf16_f32 v170, v124, v125
    v_cvt_pk_bf16_f32 v171, v126, v127
    s_waitcnt lgkmcnt(0)
    v_mfma_f32_32x32x8_bf16 v[112:127], v[40:41], v[32:33], 0
    ds_read2st64_b64 v[156:159], v11 offset0:40 offset1:41
    s_mov_b64 exec, s[26:27]
    ds_read_b64 v[38:39], v11 offset:21504
    s_mov_b64 exec, s[24:25]
    ds_read_b128 v[52:55], v12 offset:15360
    ds_read_b128 v[56:59], v12 offset:16000
    s_mov_b64 exec, -1
    v_exp_f32 v128, v128
    v_exp_f32 v129, v129
    v_exp_f32 v130, v130
    v_exp_f32 v131, v131
    v_cvt_pk_bf16_f32 v60, v128, v129
    v_cvt_pk_bf16_f32 v61, v130, v131
    v_mfma_f32_32x32x16_bf16 v[112:127], v[160:163], v[144:147], v[112:127]
    buffer_load_dwordx4 v6, s[12:15], s34 offen sc1 lds
    s_add_u32 m0, m0, 8192
    s_add_u32 s34, s34, 8192
    v_exp_f32 v132, v132
    v_exp_f32 v133, v133
    v_exp_f32 v134, v134
    v_exp_f32 v135, v135
    v_cvt_pk_bf16_f32 v62, v132, v133
    v_cvt_pk_bf16_f32 v63, v134, v135
    v_mfma_f32_32x32x16_bf16 v[68:83], v[44:47], v[164:167], v[68:83]
    v_exp_f32 v136, v136
    v_exp_f32 v137, v137
    v_exp_f32 v138, v138
    v_exp_f32 v139, v139
    v_cvt_pk_bf16_f32 v64, v136, v137
    v_cvt_pk_bf16_f32 v65, v138, v139
    v_mfma_f32_32x32x16_bf16 v[68:83], v[48:51], v[168:171], v[68:83]
    v_exp_f32 v140, v140
    v_exp_f32 v141, v141
    v_exp_f32 v142, v142
    v_exp_f32 v143, v143
    v_cvt_pk_bf16_f32 v66, v140, v141
    v_cvt_pk_bf16_f32 v67, v142, v143
    v_mfma_f32_32x32x8_bf16 v[128:143], v[40:41], v[34:35], 0
    v_exp_f32 v112, v112
    v_exp_f32 v113, v113
    v_exp_f32 v114, v114
    v_exp_f32 v115, v115
    v_cvt_pk_bf16_f32 v164, v112, v113
    v_cvt_pk_bf16_f32 v165, v114, v115
    v_mfma_f32_32x32x16_bf16 v[128:143], v[160:163], v[148:151], v[128:143]
    buffer_load_dwordx4 v6, s[12:15], s34 offen sc1 lds
    s_add_u32 m0, m0, 8192
    s_add_u32 s34, s34, 8192
    v_exp_f32 v116, v116
    v_exp_f32 v117, v117
    v_exp_f32 v118, v118
    v_exp_f32 v119, v119
    v_cvt_pk_bf16_f32 v166, v116, v117
    v_cvt_pk_bf16_f32 v167, v118, v119
    v_mfma_f32_32x32x16_bf16 v[84:99], v[44:47], v[60:63], v[84:99]
    v_exp_f32 v120, v120
    v_exp_f32 v121, v121
    v_exp_f32 v122, v122
    v_exp_f32 v123, v123
    v_cvt_pk_bf16_f32 v168, v120, v121
    v_cvt_pk_bf16_f32 v169, v122, v123
    v_mfma_f32_32x32x16_bf16 v[84:99], v[48:51], v[64:67], v[84:99]
    s_cbranch_vccz L_sk_59
    buffer_load_dwordx2 v[210:211], v30, s[12:15], s45 offen offset:128 sc1
    buffer_load_dwordx2 v[212:213], v30, s[12:15], s45 offen offset:1024 sc1
L_sk_59:
    v_exp_f32 v124, v124
    v_exp_f32 v125, v125
    v_exp_f32 v126, v126
    v_exp_f32 v127, v127
    v_cvt_pk_bf16_f32 v170, v124, v125
    v_cvt_pk_bf16_f32 v171, v126, v127
    s_waitcnt lgkmcnt(0)
    v_mfma_f32_32x32x8_bf16 v[112:127], v[38:39], v[32:33], 0
    ds_read2st64_b64 v[160:163], v11 offset0:50 offset1:51
    s_mov_b64 exec, s[26:27]
    ds_read_b64 v[40:41], v11 offset:26624
    s_mov_b64 exec, s[24:25]
    ds_read_b128 v[44:47], v12 offset:20480
    ds_read_b128 v[48:51], v12 offset:21120
    s_mov_b64 exec, -1
    v_exp_f32 v128, v128
    v_exp_f32 v129, v129
    v_exp_f32 v130, v130
    v_exp_f32 v131, v131
    v_cvt_pk_bf16_f32 v60, v128, v129
    v_cvt_pk_bf16_f32 v61, v130, v131
    v_mfma_f32_32x32x16_bf16 v[112:127], v[156:159], v[144:147], v[112:127]
    buffer_load_dwordx4 v6, s[12:15], s34 offen sc1 lds
    s_add_u32 m0, m0, 8192
    s_add_u32 s34, s34, 8192
    v_exp_f32 v132, v132
    v_exp_f32 v133, v133
    v_exp_f32 v134, v134
    v_exp_f32 v135, v135
    v_cvt_pk_bf16_f32 v62, v132, v133
    v_cvt_pk_bf16_f32 v63, v134, v135
    v_mfma_f32_32x32x16_bf16 v[68:83], v[52:55], v[164:167], v[68:83]
    v_exp_f32 v136, v136
    v_exp_f32 v137, v137
    v_exp_f32 v138, v138
    v_exp_f32 v139, v139
    v_cvt_pk_bf16_f32 v64, v136, v137
    v_cvt_pk_bf16_f32 v65, v138, v139
    v_mfma_f32_32x32x16_bf16 v[68:83], v[56:59], v[168:171], v[68:83]
    v_exp_f32 v140, v140
    v_exp_f32 v141, v141
    v_exp_f32 v142, v142
    v_exp_f32 v143, v143
    v_cvt_pk_bf16_f32 v66, v140, v141
    v_cvt_pk_bf16_f32 v67, v142, v143
    v_mfma_f32_32x32x8_bf16 v[128:143], v[38:39], v[34:35], 0
    s_setprio 2
    v_exp_f32 v112, v112
    v_exp_f32 v113, v113
    v_exp_f32 v114, v114
    v_exp_f32 v115, v115
    v_cvt_pk_bf16_f32 v164, v112, v113
    v_cvt_pk_bf16_f32 v165, v114, v115
    v_mfma_f32_32x32x16_bf16 v[128:143], v[156:159], v[148:151], v[128:143]
    buffer_load_dwordx4 v6, s[12:15], s34 offen sc1 lds
    s_add_u32 m0, m0, 8192
    s_add_u32 s34, s34, 8192
    v_exp_f32 v116, v116
    v_exp_f32 v117, v117
    v_exp_f32 v118, v118
    v_exp_f32 v119, v119
    v_cvt_pk_bf16_f32 v166, v116, v117
    v_cvt_pk_bf16_f32 v167, v118, v119
    v_mfma_f32_32x32x16_bf16 v[84:99], v[52:55], v[60:63], v[84:99]
    v_exp_f32 v120, v120
    v_exp_f32 v121, v121
    v_exp_f32 v122, v122
    v_exp_f32 v123, v123
    v_cvt_pk_bf16_f32 v168, v120, v121
    v_cvt_pk_bf16_f32 v169, v122, v123
    v_mfma_f32_32x32x16_bf16 v[84:99], v[56:59], v[64:67], v[84:99]
    s_cbranch_vccz L_sk_60
    buffer_load_dwordx2 v[214:215], v30, s[12:15], s45 offen offset:1152 sc1
    buffer_load_dwordx4 v[176:179], v6, s[12:15], s44 offen offset:0 sc1
L_sk_60:
    v_exp_f32 v124, v124
    v_exp_f32 v125, v125
    v_exp_f32 v126, v126
    v_exp_f32 v127, v127
    v_cvt_pk_bf16_f32 v170, v124, v125
    v_cvt_pk_bf16_f32 v171, v126, v127
    s_waitcnt lgkmcnt(0)
    v_mfma_f32_32x32x8_bf16 v[112:127], v[40:41], v[32:33], 0
    ds_read2st64_b64 v[156:159], v11 offset0:60 offset1:61
    s_mov_b64 exec, s[26:27]
    ds_read_b64 v[38:39], v11 offset:31744
    s_mov_b64 exec, s[24:25]
    ds_read_b128 v[52:55], v12 offset:25600
    ds_read_b128 v[56:59], v12 offset:26240
    s_mov_b64 exec, -1
    v_exp_f32 v128, v128
    v_exp_f32 v129, v129
    v_exp_f32 v130, v130
    v_exp_f32 v131, v131
    v_cvt_pk_bf16_f32 v60, v128, v129
    v_cvt_pk_bf16_f32 v61, v130, v131
    v_mfma_f32_32x32x16_bf16 v[112:127], v[160:163], v[144:147], v[112:127]
    buffer_load_dwordx4 v6, s[12:15], s34 offen sc1 lds
    s_add_u32 m0, m0, 8192
    s_add_u32 s34, s34, 8192
    v_exp_f32 v132, v132
    v_exp_f32 v133, v133
    v_exp_f32 v134, v134
    v_exp_f32 v135, v135
    v_cvt_pk_bf16_f32 v62, v132, v133
    v_cvt_pk_bf16_f32 v63, v134, v135
    v_mfma_f32_32x32x16_bf16 v[68:83], v[44:47], v[164:167], v[68:83]
    v_exp_f32 v136, v136
    v_exp_f32 v137, v137
    v_exp_f32 v138, v138
    v_exp_f32 v139, v139
    v_cvt_pk_bf16_f32 v64, v136, v137
    v_cvt_pk_bf16_f32 v65, v138, v139
    v_mfma_f32_32x32x16_bf16 v[68:83], v[48:51], v[168:171], v[68:83]
    v_exp_f32 v140, v140
    v_exp_f32 v141, v141
    v_exp_f32 v142, v142
    v_exp_f32 v143, v143
    v_cvt_pk_bf16_f32 v66, v140, v141
    v_cvt_pk_bf16_f32 v67, v142, v143
    v_mfma_f32_32x32x8_bf16 v[128:143], v[40:41], v[34:35], 0
    v_exp_f32 v112, v112
    v_exp_f32 v113, v113
    v_exp_f32 v114, v114
    v_exp_f32 v115, v115
    v_cvt_pk_bf16_f32 v164, v112, v113
    v_cvt_pk_bf16_f32 v165, v114, v115
    v_mfma_f32_32x32x16_bf16 v[128:143], v[160:163], v[148:151], v[128:143]
    buffer_load_dwordx4 v6, s[12:15], s34 offen sc1 lds
    s_add_u32 m0, m0, 8192
    s_add_u32 s34, s34, 8192
    v_exp_f32 v116, v116
    v_exp_f32 v117, v117
    v_exp_f32 v118, v118
    v_exp_f32 v119, v119
    v_cvt_pk_bf16_f32 v166, v116, v117
    v_cvt_pk_bf16_f32 v167, v118, v119
    v_mfma_f32_32x32x16_bf16 v[84:99], v[44:47], v[60:63], v[84:99]
    v_exp_f32 v120, v120
    v_exp_f32 v121, v121
    v_exp_f32 v122, v122
    v_exp_f32 v123, v123
    v_cvt_pk_bf16_f32 v168, v120, v121
    v_cvt_pk_bf16_f32 v169, v122, v123
    v_mfma_f32_32x32x16_bf16 v[84:99], v[48:51], v[64:67], v[84:99]
    s_cbranch_vccz L_sk_61
    buffer_load_dwordx4 v[180:183], v6, s[12:15], s44 offen offset:1024 sc1
    buffer_load_dwordx4 v[184:187], v6, s[12:15], s44 offen offset:2048 sc1
L_sk_61:
    v_exp_f32 v124, v124
    v_exp_f32 v125, v125
    v_exp_f32 v126, v126
    v_exp_f32 v127, v127
    v_cvt_pk_bf16_f32 v170, v124, v125
    v_cvt_pk_bf16_f32 v171, v126, v127
    s_waitcnt lgkmcnt(0)
    v_mfma_f32_32x32x8_bf16 v[112:127], v[38:39], v[32:33], 0
    ds_read2st64_b64 v[160:163], v11 offset0:70 offset1:71
    s_mov_b64 exec, s[26:27]
    ds_read_b64 v[40:41], v11 offset:36864
    s_mov_b64 exec, s[24:25]
    ds_read_b128 v[44:47], v12 offset:30720
    ds_read_b128 v[48:51], v12 offset:31360
    s_mov_b64 exec, -1
    v_exp_f32 v128, v128
    v_exp_f32 v129, v129
    v_exp_f32 v130, v130
    v_exp_f32 v131, v131
    v_cvt_pk_bf16_f32 v60, v128, v129
    v_cvt_pk_bf16_f32 v61, v130, v131
    v_mfma_f32_32x32x16_bf16 v[112:127], v[156:159], v[144:147], v[112:127]
    buffer_load_dwordx4 v6, s[12:15], s34 offen sc1 lds
    s_add_u32 m0, m0, 8192
    s_add_u32 s34, s34, 8192
    v_exp_f32 v132, v132
    v_exp_f32 v133, v133
    v_exp_f32 v134, v134
    v_exp_f32 v135, v135
    v_cvt_pk_bf16_f32 v62, v132, v133
    v_cvt_pk_bf16_f32 v63, v134, v135
    v_mfma_f32_32x32x16_bf16 v[68:83], v[52:55], v[164:167], v[68:83]
    v_exp_f32 v136, v136
    v_exp_f32 v137, v137
    v_exp_f32 v138, v138
    v_exp_f32 v139, v139
    v_cvt_pk_bf16_f32 v64, v136, v137
    v_cvt_pk_bf16_f32 v65, v138, v139
    v_mfma_f32_32x32x16_bf16 v[68:83], v[56:59], v[168:171], v[68:83]
    v_exp_f32 v140, v140
    v_exp_f32 v141, v141
    v_exp_f32 v142, v142
    v_exp_f32 v143, v143
    v_cvt_pk_bf16_f32 v66, v140, v141
    v_cvt_pk_bf16_f32 v67, v142, v143
    v_mfma_f32_32x32x8_bf16 v[128:143], v[38:39], v[34:35], 0
    s_setprio 1
    v_exp_f32 v112, v112
    v_exp_f32 v113, v113
    v_exp_f32 v114, v114
    v_exp_f32 v115, v115
    v_cvt_pk_bf16_f32 v164, v112, v113
    v_cvt_pk_bf16_f32 v165, v114, v115
    v_mfma_f32_32x32x16_bf16 v[128:143], v[156:159], v[148:151], v[128:143]
    s_cmp_ge_u32 s16, 4
    s_cselect_b32 m0, 163840, m0
    s_nop 0
    buffer_load_dwordx4 v6, s[12:15], s34 offen sc1 lds
    v_exp_f32 v116, v116
    v_exp_f32 v117, v117
    v_exp_f32 v118, v118
    v_exp_f32 v119, v119
    v_cvt_pk_bf16_f32 v166, v116, v117
    v_cvt_pk_bf16_f32 v167, v118, v119
    v_mfma_f32_32x32x16_bf16 v[84:99], v[52:55], v[60:63], v[84:99]
    v_exp_f32 v120, v120
    v_exp_f32 v121, v121
    v_exp_f32 v122, v122
    v_exp_f32 v123, v123
    v_cvt_pk_bf16_f32 v168, v120, v121
    v_cvt_pk_bf16_f32 v169, v122, v123
    v_mfma_f32_32x32x16_bf16 v[84:99], v[56:59], v[64:67], v[84:99]
    v_exp_f32 v124, v124
    v_exp_f32 v125, v125
    v_exp_f32 v126, v126
    v_exp_f32 v127, v127
    v_cvt_pk_bf16_f32 v170, v124, v125
    v_cvt_pk_bf16_f32 v171, v126, v127
    s_waitcnt lgkmcnt(0)
    v_mfma_f32_32x32x8_bf16 v[112:127], v[40:41], v[34:35], 0
    s_mov_b64 exec, s[24:25]
    ds_read_b128 v[52:55], v12 offset:35840
    ds_read_b128 v[56:59], v12 offset:36480
    s_mov_b64 exec, -1
    v_exp_f32 v128, v128
    v_exp_f32 v129, v129
    v_exp_f32 v130, v130
    v_exp_f32 v131, v131
    v_cvt_pk_bf16_f32 v60, v128, v129
    v_cvt_pk_bf16_f32 v61, v130, v131
    v_mfma_f32_32x32x16_bf16 v[112:127], v[160:163], v[148:151], v[112:127]
    v_exp_f32 v132, v132
    v_exp_f32 v133, v133
    v_exp_f32 v134, v134
    v_exp_f32 v135, v135
    v_cvt_pk_bf16_f32 v62, v132, v133
    v_cvt_pk_bf16_f32 v63, v134, v135
    v_mfma_f32_32x32x16_bf16 v[68:83], v[44:47], v[164:167], v[68:83]
    s_mul_i32 s35, s16, 2560
    s_lshl_b32 s36, s16, 7
    s_add_u32 s36, s36, 122880
    v_add_u32 v2, s35, v6
    v_lshl_add_u32 v3, v1, 2, s36
    s_xor_b32 s37, s16, 4
    s_mul_i32 s35, s37, 2560
    s_xor_b32 s36, s36, 512
    v_add_u32 v16, s35, v6
    v_and_b32 v15, 31, v1
    v_lshl_add_u32 v15, v15, 2, s36
    s_and_b32 s35, s16, 3
    s_mul_i32 s35, s35, 5120
    v_add_u32 v11, s35, v6
    s_add_u32 s34, s33, 819200
    s_add_u32 m0, s76, 124928
    v_mov_b32 v4, 123904
    ds_write_b32 v4, v28
    v_exp_f32 v136, v136
    v_exp_f32 v137, v137
    v_exp_f32 v138, v138
    v_exp_f32 v139, v139
    v_cvt_pk_bf16_f32 v64, v136, v137
    v_cvt_pk_bf16_f32 v65, v138, v139
    v_mfma_f32_32x32x16_bf16 v[68:83], v[48:51], v[168:171], v[68:83]
    v_exp_f32 v140, v140
    v_exp_f32 v141, v141
    v_exp_f32 v142, v142
    v_exp_f32 v143, v143
    v_cvt_pk_bf16_f32 v66, v140, v141
    v_cvt_pk_bf16_f32 v67, v142, v143
    v_mfma_f32_32x32x8_bf16 v[128:143], v[40:41], v[32:33], 0
    s_setprio 0
    v_exp_f32 v112, v112
    v_exp_f32 v113, v113
    v_exp_f32 v114, v114
    v_exp_f32 v115, v115
    v_cvt_pk_bf16_f32 v164, v112, v113
    v_cvt_pk_bf16_f32 v165, v114, v115
    v_mfma_f32_32x32x16_bf16 v[128:143], v[160:163], v[144:147], v[128:143]
    v_exp_f32 v116, v116
    v_exp_f32 v117, v117
    v_exp_f32 v118, v118
    v_exp_f32 v119, v119
    v_cvt_pk_bf16_f32 v166, v116, v117
    v_cvt_pk_bf16_f32 v167, v118, v119
    v_mfma_f32_32x32x16_bf16 v[84:99], v[44:47], v[60:63], v[84:99]
    v_exp_f32 v120, v120
    v_exp_f32 v121, v121
    v_exp_f32 v122, v122
    v_exp_f32 v123, v123
    v_cvt_pk_bf16_f32 v168, v120, v121
    v_cvt_pk_bf16_f32 v169, v122, v123
    v_mfma_f32_32x32x16_bf16 v[84:99], v[48:51], v[64:67], v[84:99]
    v_exp_f32 v124, v124
    v_exp_f32 v125, v125
    v_exp_f32 v126, v126
    v_exp_f32 v127, v127
    v_cvt_pk_bf16_f32 v170, v124, v125
    v_cvt_pk_bf16_f32 v171, v126, v127
    s_waitcnt lgkmcnt(0)
    v_mfma_f32_32x32x16_bf16 v[84:99], v[52:55], v[164:167], v[84:99]
    v_exp_f32 v128, v128
    v_exp_f32 v129, v129
    v_exp_f32 v130, v130
    v_exp_f32 v131, v131
    v_cvt_pk_bf16_f32 v60, v128, v129
    v_cvt_pk_bf16_f32 v61, v130, v131
    v_mfma_f32_32x32x16_bf16 v[84:99], v[56:59], v[168:171], v[84:99]
    v_exp_f32 v132, v132
    v_exp_f32 v133, v133
    v_exp_f32 v134, v134
    v_exp_f32 v135, v135
    v_cvt_pk_bf16_f32 v62, v132, v133
    v_cvt_pk_bf16_f32 v63, v134, v135
    v_exp_f32 v136, v136
    v_exp_f32 v137, v137
    v_exp_f32 v138, v138
    v_exp_f32 v139, v139
    v_cvt_pk_bf16_f32 v64, v136, v137
    v_cvt_pk_bf16_f32 v65, v138, v139
    ds_write_b128 v2, v[84:87]
    ds_write_b128 v2, v[88:91] offset:1024
    s_mov_b64 exec, s[26:27]
    ds_write_b128 v2, v[92:95] offset:2048
    ds_write_b32 v3, v96
    s_mov_b64 exec, -1
    v_exp_f32 v140, v140
    v_exp_f32 v141, v141
    v_exp_f32 v142, v142
    v_exp_f32 v143, v143
    v_cvt_pk_bf16_f32 v66, v140, v141
    v_cvt_pk_bf16_f32 v67, v142, v143
    s_waitcnt vmcnt(0) lgkmcnt(0)
    v_mfma_f32_32x32x16_bf16 v[68:83], v[52:55], v[60:63], v[68:83]
    v_mfma_f32_32x32x16_bf16 v[68:83], v[56:59], v[64:67], v[68:83]
    s_barrier
    s_setprio 0
    ds_read_b128 v[112:115], v16 offset:0
    ds_read_b128 v[116:119], v16 offset:1024
    ds_read_b128 v[120:123], v16 offset:2048
    ds_read_b32 v124, v15
    s_nop 4
    s_waitcnt lgkmcnt(3)
    v_add_f32 v68, v68, v112
    v_add_f32 v69, v69, v113
    v_add_f32 v70, v70, v114
    v_add_f32 v71, v71, v115
    s_waitcnt lgkmcnt(2)
    v_add_f32 v72, v72, v116
    v_add_f32 v73, v73, v117
    v_add_f32 v74, v74, v118
    v_add_f32 v75, v75, v119
    s_waitcnt lgkmcnt(1)
    s_mov_b64 exec, s[26:27]
    v_add_f32 v76, v76, v120
    v_add_f32 v77, v77, v121
    v_add_f32 v78, v78, v122
    v_add_f32 v79, v79, v123
    s_mov_b64 exec, -1
    s_waitcnt lgkmcnt(0)
    v_add_f32 v80, v80, v124
    v_add_f32 v2, abs(v68), abs(v69)
    v_add_f32 v3, abs(v70), abs(v71)
    v_add_f32 v2, v2, abs(v72)
    v_add_f32 v3, v3, abs(v73)
    v_add_f32 v2, v2, abs(v74)
    v_add_f32 v3, v3, abs(v75)
    v_add_f32 v2, v2, abs(v76)
    v_add_f32 v3, v3, abs(v77)
    v_add_f32 v2, v2, abs(v78)
    v_add_f32 v3, v3, abs(v79)
    v_add_f32 v2, v2, v3
    s_mov_b32 s44, 0x7b800000
    s_mov_b32 s45, 0x35800000
    s_mov_b32 s46, 0x7f800000
    v_cmp_nlt_f32 s[48:49], v80, s44
    v_cmp_ngt_f32 s[50:51], v80, s45
    v_cmp_nlt_f32 s[52:53], v2, s46
    s_or_b64 s[48:49], s[48:49], s[50:51]
    s_or_b64 s[48:49], s[48:49], s[52:53]
    s_cbranch_scc1 L_slow_66
L_ret_67:
    v_rcp_f32 v2, v80
    s_nop 0
    v_mul_f32 v68, v2, v68
    v_mul_f32 v69, v2, v69
    v_mul_f32 v70, v2, v70
    v_mul_f32 v71, v2, v71
    v_mul_f32 v72, v2, v72
    v_mul_f32 v73, v2, v73
    v_mul_f32 v74, v2, v74
    v_mul_f32 v75, v2, v75
    v_mul_f32 v76, v2, v76
    v_mul_f32 v77, v2, v77
    v_mul_f32 v78, v2, v78
    v_mul_f32 v79, v2, v79
    v_cvt_pk_bf16_f32 v68, v68, v69
    v_cvt_pk_bf16_f32 v69, v70, v71
    v_cvt_pk_bf16_f32 v70, v72, v73
    v_cvt_pk_bf16_f32 v71, v74, v75
    v_cvt_pk_bf16_f32 v72, v76, v77
    v_cvt_pk_bf16_f32 v73, v78, v79
    buffer_store_dwordx4 v[68:71], v13, s[12:15], s80 offen sc1
    s_mov_b64 exec, s[26:27]
    buffer_store_dwordx2 v[72:73], v14, s[12:15], s81 offen sc1
    s_mov_b64 exec, -1
    buffer_load_dwordx4 v6, s[12:15], s34 offen sc1 lds
    s_add_u32 m0, m0, 8192
    s_add_u32 s34, s34, 8192
    buffer_load_dwordx4 v6, s[12:15], s34 offen sc1 lds
    s_add_u32 m0, m0, 8192
    s_add_u32 s34, s34, 8192
    buffer_load_dwordx4 v6, s[12:15], s34 offen sc1 lds
    s_add_u32 m0, m0, 8192
    s_add_u32 s34, s34, 8192
    s_cmp_ge_u32 s16, 6
    s_cselect_b32 m0, 163840, m0
    v_mov_b32 v3, 1
    buffer_load_dwordx4 v6, s[12:15], s34 offen sc1 lds
    s_mov_b32 s42, 1
    s_mov_b32 s41, s85
    s_add_u32 s34, s33, 849920
    s_add_u32 m0, s76, 51200
    s_mov_b64 vcc, -1
    ds_read_b128 v[32:35], v21 offset:0
    ds_read_b128 v[36:39], v21 offset:1024
    ds_read_b128 v[40:43], v21 offset:2048
    ds_read_b128 v[44:47], v21 offset:3072
    ds_read_b128 v[48:51], v21 offset:4096
    ds_read_b128 v[52:55], v21 offset:5120
    ds_read_b128 v[56:59], v21 offset:6144
    ds_read_b128 v[60:63], v21 offset:7168
    ds_read_b128 v[64:67], v21 offset:8192
    ds_read_b128 v[68:71], v21 offset:9216
    ds_read_b128 v[72:75], v21 offset:10240
    ds_read_b128 v[76:79], v21 offset:11264
    ds_read_b128 v[80:83], v21 offset:12288
    ds_read_b128 v[84:87], v21 offset:13312
    ds_read_b128 v[88:91], v21 offset:14336
    ds_read_b128 v[92:95], v21 offset:15360
    ds_read_b128 v[96:99], v21 offset:16384
    ds_read_b128 v[100:103], v21 offset:17408
    ds_read_b128 v[104:107], v21 offset:18432
    ds_read_b128 v[108:111], v21 offset:19456
    ds_read_b128 v[112:115], v21 offset:20480
    ds_read_b128 v[116:119], v21 offset:21504
    ds_read_b128 v[120:123], v21 offset:22528
    ds_read_b128 v[124:127], v21 offset:23552
    ds_read_b128 v[128:131], v21 offset:24576
    ds_read_b128 v[132:135], v21 offset:25600
    ds_read_b128 v[136:139], v21 offset:26624
    ds_read_b128 v[140:143], v21 offset:27648
    ds_read_b128 v[144:147], v21 offset:28672
    ds_read_b128 v[148:151], v21 offset:29696
    ds_read_b128 v[152:155], v21 offset:30720
    ds_read_b128 v[156:159], v21 offset:31744
    ds_read_b128 v[160:163], v21 offset:32768
    ds_read_b128 v[164:167], v21 offset:33792
    ds_read_b128 v[168:171], v21 offset:34816
    s_waitcnt vmcnt(4) lgkmcnt(0)
    s_barrier
    buffer_atomic_add v3, v25, s[12:15], s84 offen offset:1024 sc1
    s_cmp_lg_u32 s47, 32
    s_cbranch_scc1 L_lateO_62
L_backO_63:
    s_cmp_gt_u32 s42, s72
    s_cbranch_scc1 L_wdma_68
L_wb0_69:
    s_cbranch_vccnz L_phb_71
    s_waitcnt vmcnt(11)
L_phb_71:
    s_waitcnt lgkmcnt(15)
    v_mfma_f32_16x16x32_bf16 v[216:219], v[32:35], v[188:191], 0
    v_mfma_f32_16x16x32_bf16 v[220:223], v[36:39], v[188:191], 0
    v_mfma_f32_16x16x32_bf16 v[224:227], v[40:43], v[188:191], 0
    v_mfma_f32_16x16x32_bf16 v[228:231], v[44:47], v[188:191], 0
    v_mfma_f32_16x16x32_bf16 v[232:235], v[48:51], v[188:191], 0
    s_cbranch_vccnz L_phb_72
    s_waitcnt vmcnt(10)
L_phb_72:
    s_waitcnt lgkmcnt(15)
    v_mfma_f32_16x16x32_bf16 v[216:219], v[52:55], v[192:195], v[216:219]
    ds_read_b128 v[32:35], v20 offset:0
    v_mfma_f32_16x16x32_bf16 v[220:223], v[56:59], v[192:195], v[220:223]
    ds_read_b128 v[36:39], v20 offset:1024
    v_mfma_f32_16x16x32_bf16 v[224:227], v[60:63], v[192:195], v[224:227]
    ds_read_b128 v[40:43], v20 offset:2048
    v_mfma_f32_16x16x32_bf16 v[228:231], v[64:67], v[192:195], v[228:231]
    ds_read_b128 v[44:47], v20 offset:3072
    v_mfma_f32_16x16x32_bf16 v[232:235], v[68:71], v[192:195], v[232:235]
    ds_read_b128 v[48:51], v20 offset:4096
    s_cbranch_vccnz L_phb_73
    s_waitcnt vmcnt(9)
L_phb_73:
    s_waitcnt lgkmcnt(15)
    v_mfma_f32_16x16x32_bf16 v[216:219], v[72:75], v[196:199], v[216:219]
    ds_read_b128 v[52:55], v20 offset:5120
    v_mfma_f32_16x16x32_bf16 v[220:223], v[76:79], v[196:199], v[220:223]
    ds_read_b128 v[56:59], v20 offset:6144
    v_mfma_f32_16x16x32_bf16 v[224:227], v[80:83], v[196:199], v[224:227]
    ds_read_b128 v[60:63], v20 offset:7168
    v_mfma_f32_16x16x32_bf16 v[228:231], v[84:87], v[196:199], v[228:231]
    ds_read_b128 v[64:67], v20 offset:8192
    v_mfma_f32_16x16x32_bf16 v[232:235], v[88:91], v[196:199], v[232:235]
    ds_read_b128 v[68:71], v20 offset:9216
    s_cbranch_vccnz L_phb_74
    s_waitcnt vmcnt(8)
L_phb_74:
    s_waitcnt lgkmcnt(15)
    v_mfma_f32_16x16x32_bf16 v[216:219], v[92:95], v[200:203], v[216:219]
    ds_read_b128 v[72:75], v20 offset:10240
    v_mfma_f32_16x16x32_bf16 v[220:223], v[96:99], v[200:203], v[220:223]
    ds_read_b128 v[76:79], v20 offset:11264
    v_mfma_f32_16x16x32_bf16 v[224:227], v[100:103], v[200:203], v[224:227]
    ds_read_b128 v[80:83], v20 offset:12288
    v_mfma_f32_16x16x32_bf16 v[228:231], v[104:107], v[200:203], v[228:231]
    ds_read_b128 v[84:87], v20 offset:13312
    v_mfma_f32_16x16x32_bf16 v[232:235], v[108:111], v[200:203], v[232:235]
    ds_read_b128 v[88:91], v20 offset:14336
    s_cbranch_vccnz L_phb_75
    s_waitcnt vmcnt(7)
L_phb_75:
    s_waitcnt lgkmcnt(15)
    v_mfma_f32_16x16x32_bf16 v[216:219], v[112:115], v[204:207], v[216:219]
    v_mfma_f32_16x16x32_bf16 v[220:223], v[116:119], v[204:207], v[220:223]
    v_mfma_f32_16x16x32_bf16 v[224:227], v[120:123], v[204:207], v[224:227]
    v_mfma_f32_16x16x32_bf16 v[228:231], v[124:127], v[204:207], v[228:231]
    v_mfma_f32_16x16x32_bf16 v[232:235], v[128:131], v[204:207], v[232:235]
    s_cbranch_vccnz L_phb_76
    s_waitcnt vmcnt(5)
L_phb_76:
    s_waitcnt lgkmcnt(15)
    v_mfma_f32_16x16x32_bf16 v[216:219], v[132:135], v[208:211], v[216:219]
    v_mfma_f32_16x16x32_bf16 v[220:223], v[136:139], v[208:211], v[220:223]
    v_mfma_f32_16x16x32_bf16 v[224:227], v[140:143], v[208:211], v[224:227]
    v_mfma_f32_16x16x32_bf16 v[228:231], v[144:147], v[208:211], v[228:231]
    v_mfma_f32_16x16x32_bf16 v[232:235], v[148:151], v[208:211], v[232:235]
    s_cbranch_vccnz L_phb_77
    s_waitcnt vmcnt(3)
L_phb_77:
    s_waitcnt lgkmcnt(15)
    v_mfma_f32_16x16x32_bf16 v[216:219], v[152:155], v[212:215], v[216:219]
    v_mfma_f32_16x16x32_bf16 v[220:223], v[156:159], v[212:215], v[220:223]
    v_mfma_f32_16x16x32_bf16 v[224:227], v[160:163], v[212:215], v[224:227]
    v_mfma_f32_16x16x32_bf16 v[228:231], v[164:167], v[212:215], v[228:231]
    v_mfma_f32_16x16x32_bf16 v[232:235], v[168:171], v[212:215], v[232:235]
    s_cbranch_vccnz L_phb_78
    s_waitcnt vmcnt(2)
L_phb_78:
    s_waitcnt lgkmcnt(10)
    v_mfma_f32_16x16x32_bf16 v[216:219], v[32:35], v[176:179], v[216:219]
    v_mfma_f32_16x16x32_bf16 v[220:223], v[36:39], v[176:179], v[220:223]
    v_mfma_f32_16x16x32_bf16 v[224:227], v[40:43], v[176:179], v[224:227]
    v_mfma_f32_16x16x32_bf16 v[228:231], v[44:47], v[176:179], v[228:231]
    v_mfma_f32_16x16x32_bf16 v[232:235], v[48:51], v[176:179], v[232:235]
    s_cbranch_vccnz L_phb_79
    s_waitcnt vmcnt(1)
L_phb_79:
    s_waitcnt lgkmcnt(5)
    v_mfma_f32_16x16x32_bf16 v[216:219], v[52:55], v[180:183], v[216:219]
    v_mfma_f32_16x16x32_bf16 v[220:223], v[56:59], v[180:183], v[220:223]
    v_mfma_f32_16x16x32_bf16 v[224:227], v[60:63], v[180:183], v[224:227]
    v_mfma_f32_16x16x32_bf16 v[228:231], v[64:67], v[180:183], v[228:231]
    v_mfma_f32_16x16x32_bf16 v[232:235], v[68:71], v[180:183], v[232:235]
    s_cbranch_vccnz L_phb_80
    s_waitcnt vmcnt(0)
L_phb_80:
    s_waitcnt lgkmcnt(0)
    v_mfma_f32_16x16x32_bf16 v[216:219], v[72:75], v[184:187], v[216:219]
    v_mfma_f32_16x16x32_bf16 v[220:223], v[76:79], v[184:187], v[220:223]
    v_mfma_f32_16x16x32_bf16 v[224:227], v[80:83], v[184:187], v[224:227]
    v_mfma_f32_16x16x32_bf16 v[228:231], v[84:87], v[184:187], v[228:231]
    v_mfma_f32_16x16x32_bf16 v[232:235], v[88:91], v[184:187], v[232:235]
    s_and_b32 s44, s42, s72
    s_cbranch_scc1 L_wdma_68
L_wb1_70:
    s_cbranch_vccz L_wb1_70_n
    buffer_load_dword v17, v28, s[12:15], s85 offen offset:1024 sc1
L_wb1_70_n:
    s_cmp_eq_u32 s42, 0
    s_cbranch_scc1 L_p2e_83
    s_mov_b32 s46, 2621440
    s_add_u32 s41, s85, 1024
    s_mov_b64 vcc, 0
    v_add_u32 v20, 104448, v20
    s_cmp_eq_u32 s72, 1
    s_nop 0
    s_cbranch_scc1 L_plo_81
    ds_write_b128 v11, v[216:219] offset:0
    ds_write_b128 v11, v[220:223] offset:1024
    ds_write_b128 v11, v[224:227] offset:2048
    ds_write_b128 v11, v[228:231] offset:3072
    ds_write_b128 v11, v[232:235] offset:4096
L_plo_81:
    v_mov_b32 v4, 123904
    s_waitcnt vmcnt(0)
    v_readfirstlane_b32 s47, v17
    s_mov_b32 s42, 0
    s_waitcnt lgkmcnt(0)
    s_barrier
    s_cmp_lg_u32 s47, 32
    s_cbranch_scc1 L_nl_84
    ds_write_b32 v4, v3
    s_lshl_b32 s44, s72, 13
    s_add_u32 s44, s44, s98
    s_add_u32 s44, s44, s46
    s_add_u32 s48, s44, 4096
    s_lshl_b32 s45, s72, 11
    s_add_u32 s45, s45, s98
    s_add_u32 s45, s45, s46
    s_add_u32 s45, s45, 16384
    s_cmp_eq_u32 s72, 1
    s_cbranch_scc1 L_nl_84_r
    buffer_load_dwordx4 v[188:191], v6, s[12:15], s44 offen offset:3072 sc1
    ds_read_b128 v[32:35], v21 offset:0
    ds_read_b128 v[36:39], v21 offset:1024
    ds_read_b128 v[40:43], v21 offset:2048
    buffer_load_dwordx4 v[192:195], v6, s[12:15], s48 offen offset:0 sc1
    ds_read_b128 v[44:47], v21 offset:3072
    ds_read_b128 v[48:51], v21 offset:4096
    ds_read_b128 v[52:55], v21 offset:5120
    buffer_load_dwordx4 v[196:199], v6, s[12:15], s48 offen offset:1024 sc1
    ds_read_b128 v[56:59], v21 offset:6144
    ds_read_b128 v[60:63], v21 offset:7168
    ds_read_b128 v[64:67], v21 offset:8192
    buffer_load_dwordx4 v[200:203], v6, s[12:15], s48 offen offset:2048 sc1
    ds_read_b128 v[68:71], v21 offset:9216
    ds_read_b128 v[72:75], v21 offset:10240
    ds_read_b128 v[76:79], v21 offset:11264
    buffer_load_dwordx4 v[204:207], v6, s[12:15], s48 offen offset:3072 sc1
    ds_read_b128 v[80:83], v21 offset:12288
    ds_read_b128 v[84:87], v21 offset:13312
    ds_read_b128 v[88:91], v21 offset:14336
    buffer_load_dwordx2 v[208:209], v30, s[12:15], s45 offen offset:0 sc1
    ds_read_b128 v[92:95], v21 offset:15360
    ds_read_b128 v[96:99], v21 offset:16384
    ds_read_b128 v[100:103], v21 offset:17408
    buffer_load_dwordx2 v[210:211], v30, s[12:15], s45 offen offset:128 sc1
    ds_read_b128 v[104:107], v21 offset:18432
    ds_read_b128 v[108:111], v21 offset:19456
    ds_read_b128 v[112:115], v21 offset:20480
    buffer_load_dwordx2 v[212:213], v30, s[12:15], s45 offen offset:1024 sc1
    ds_read_b128 v[116:119], v21 offset:21504
    ds_read_b128 v[120:123], v21 offset:22528
    ds_read_b128 v[124:127], v21 offset:23552
    buffer_load_dwordx2 v[214:215], v30, s[12:15], s45 offen offset:1152 sc1
    ds_read_b128 v[128:131], v21 offset:24576
    ds_read_b128 v[132:135], v21 offset:25600
    ds_read_b128 v[136:139], v21 offset:26624
    buffer_load_dwordx4 v[176:179], v6, s[12:15], s44 offen offset:0 sc1
    ds_read_b128 v[140:143], v21 offset:27648
    ds_read_b128 v[144:147], v21 offset:28672
    ds_read_b128 v[148:151], v21 offset:29696
    buffer_load_dwordx4 v[180:183], v6, s[12:15], s44 offen offset:1024 sc1
    ds_read_b128 v[152:155], v21 offset:30720
    ds_read_b128 v[156:159], v21 offset:31744
    ds_read_b128 v[160:163], v21 offset:32768
    buffer_load_dwordx4 v[184:187], v6, s[12:15], s44 offen offset:2048 sc1
    ds_read_b128 v[164:167], v21 offset:33792
    ds_read_b128 v[168:171], v21 offset:34816
    s_branch L_backO_63
L_nl_84_r:
    buffer_load_dwordx4 v[188:191], v6, s[12:15], s44 offen offset:3072 sc1
    buffer_load_dwordx4 v[192:195], v6, s[12:15], s48 offen offset:0 sc1
    buffer_load_dwordx4 v[196:199], v6, s[12:15], s48 offen offset:1024 sc1
    buffer_load_dwordx4 v[200:203], v6, s[12:15], s48 offen offset:2048 sc1
    buffer_load_dwordx4 v[204:207], v6, s[12:15], s48 offen offset:3072 sc1
    buffer_load_dwordx2 v[208:209], v30, s[12:15], s45 offen offset:0 sc1
    buffer_load_dwordx2 v[210:211], v30, s[12:15], s45 offen offset:128 sc1
    buffer_load_dwordx2 v[212:213], v30, s[12:15], s45 offen offset:1024 sc1
    buffer_load_dwordx2 v[214:215], v30, s[12:15], s45 offen offset:1152 sc1
    buffer_load_dwordx4 v[176:179], v6, s[12:15], s44 offen offset:0 sc1
    buffer_load_dwordx4 v[180:183], v6, s[12:15], s44 offen offset:1024 sc1
    buffer_load_dwordx4 v[184:187], v6, s[12:15], s44 offen offset:2048 sc1
L_nl_84:
    s_cmp_lg_u32 s72, 1
    s_cbranch_scc1 L_pdn_82
    ds_read_b128 v[132:135], v11 offset:0
    ds_read_b128 v[136:139], v11 offset:1024
    ds_read_b128 v[140:143], v11 offset:2048
    ds_read_b128 v[144:147], v11 offset:3072
    ds_read_b128 v[148:151], v11 offset:4096
    s_waitcnt lgkmcnt(4)
    v_add_f32 v216, v216, v132
    v_add_f32 v217, v217, v133
    v_add_f32 v218, v218, v134
    v_add_f32 v219, v219, v135
    v_cvt_pk_bf16_f32 v240, v216, v217
    v_cvt_pk_bf16_f32 v241, v218, v219
    s_waitcnt lgkmcnt(3)
    v_add_f32 v220, v220, v136
    v_add_f32 v221, v221, v137
    v_add_f32 v222, v222, v138
    v_add_f32 v223, v223, v139
    v_cvt_pk_bf16_f32 v242, v220, v221
    v_cvt_pk_bf16_f32 v243, v222, v223
    s_waitcnt lgkmcnt(2)
    v_add_f32 v224, v224, v140
    v_add_f32 v225, v225, v141
    v_add_f32 v226, v226, v142
    v_add_f32 v227, v227, v143
    v_cvt_pk_bf16_f32 v244, v224, v225
    v_cvt_pk_bf16_f32 v245, v226, v227
    s_waitcnt lgkmcnt(1)
    v_add_f32 v228, v228, v144
    v_add_f32 v229, v229, v145
    v_add_f32 v230, v230, v146
    v_add_f32 v231, v231, v147
    v_cvt_pk_bf16_f32 v246, v228, v229
    v_cvt_pk_bf16_f32 v247, v230, v231
    s_waitcnt lgkmcnt(0)
    v_add_f32 v232, v232, v148
    v_add_f32 v233, v233, v149
    v_add_f32 v234, v234, v150
    v_add_f32 v235, v235, v151
    v_cvt_pk_bf16_f32 v248, v232, v233
    v_cvt_pk_bf16_f32 v249, v234, v235
L_pdn_82:
    ds_read_b128 v[32:35], v21 offset:0
    ds_read_b128 v[36:39], v21 offset:1024
    ds_read_b128 v[40:43], v21 offset:2048
    ds_read_b128 v[44:47], v21 offset:3072
    ds_read_b128 v[48:51], v21 offset:4096
    ds_read_b128 v[52:55], v21 offset:5120
    ds_read_b128 v[56:59], v21 offset:6144
    ds_read_b128 v[60:63], v21 offset:7168
    ds_read_b128 v[64:67], v21 offset:8192
    ds_read_b128 v[68:71], v21 offset:9216
    ds_read_b128 v[72:75], v21 offset:10240
    ds_read_b128 v[76:79], v21 offset:11264
    ds_read_b128 v[80:83], v21 offset:12288
    ds_read_b128 v[84:87], v21 offset:13312
    ds_read_b128 v[88:91], v21 offset:14336
    ds_read_b128 v[92:95], v21 offset:15360
    ds_read_b128 v[96:99], v21 offset:16384
    ds_read_b128 v[100:103], v21 offset:17408
    ds_read_b128 v[104:107], v21 offset:18432
    ds_read_b128 v[108:111], v21 offset:19456
    ds_read_b128 v[112:115], v21 offset:20480
    ds_read_b128 v[116:119], v21 offset:21504
    ds_read_b128 v[120:123], v21 offset:22528
    ds_read_b128 v[124:127], v21 offset:23552
    ds_read_b128 v[128:131], v21 offset:24576
    ds_read_b128 v[132:135], v21 offset:25600
    ds_read_b128 v[136:139], v21 offset:26624
    ds_read_b128 v[140:143], v21 offset:27648
    ds_read_b128 v[144:147], v21 offset:28672
    ds_read_b128 v[148:151], v21 offset:29696
    ds_read_b128 v[152:155], v21 offset:30720
    ds_read_b128 v[156:159], v21 offset:31744
    ds_read_b128 v[160:163], v21 offset:32768
    ds_read_b128 v[164:167], v21 offset:33792
    ds_read_b128 v[168:171], v21 offset:34816
    s_cmp_lg_u32 s47, 32
    s_cbranch_scc1 L_lateA_64
    s_branch L_backO_63
L_p2e_83:
    s_and_b32 s48, s16, 3
    s_mul_i32 s48, s48, 40960
    s_sub_u32 s48, s99, s48
    s_add_u32 s48, s48, 1280
    s_nop 1
    ds_write_b128 v8, v[216:219]
    ds_write_b128 v9, v[220:223]
    ds_write_b128 v10, v[224:227]
    ds_write_b128 v12, v[228:231]
    ds_write_b128 v13, v[232:235]
    s_cmp_lg_u32 s72, 1
    s_cbranch_scc1 L_p2e_83_w
    buffer_store_dwordx4 v[240:243], v24, s[56:59], s99 offen offset:0
    buffer_store_dwordx4 v[244:247], v24, s[56:59], s99 offen offset:16
    buffer_store_dwordx2 v[248:249], v24, s[56:59], s99 offen offset:32
L_p2e_83_w:
    s_waitcnt lgkmcnt(0)
    s_barrier
    ds_read_b128 v[32:35], v14
    ds_read_b128 v[40:43], v14 offset:20480
    ds_read_b128 v[36:39], v15
    ds_read_b128 v[44:47], v15 offset:20480
    s_waitcnt lgkmcnt(2)
    v_add_f32 v32, v32, v40
    v_add_f32 v33, v33, v41
    v_add_f32 v34, v34, v42
    v_add_f32 v35, v35, v43
    v_cvt_pk_bf16_f32 v48, v32, v33
    v_cvt_pk_bf16_f32 v49, v34, v35
    s_waitcnt lgkmcnt(0)
    v_add_f32 v36, v36, v44
    v_add_f32 v37, v37, v45
    v_add_f32 v38, v38, v46
    v_add_f32 v39, v39, v47
    v_cvt_pk_bf16_f32 v50, v36, v37
    v_cvt_pk_bf16_f32 v51, v38, v39
    buffer_store_dwordx4 v[48:51], v22, s[56:59], s48 offen
    s_xor_b32 s49, s16, 4
    s_cmp_ge_u32 s49, 2
    s_cbranch_scc1 L_pend_65
    ds_read_b128 v[52:55], v16
    ds_read_b128 v[60:63], v16 offset:20480
    ds_read_b128 v[56:59], v18
    ds_read_b128 v[64:67], v18 offset:20480
    s_waitcnt lgkmcnt(2)
    v_add_f32 v52, v52, v60
    v_add_f32 v53, v53, v61
    v_add_f32 v54, v54, v62
    v_add_f32 v55, v55, v63
    v_cvt_pk_bf16_f32 v68, v52, v53
    v_cvt_pk_bf16_f32 v69, v54, v55
    s_waitcnt lgkmcnt(0)
    v_add_f32 v56, v56, v64
    v_add_f32 v57, v57, v65
    v_add_f32 v58, v58, v66
    v_add_f32 v59, v59, v67
    v_cvt_pk_bf16_f32 v70, v56, v57
    v_cvt_pk_bf16_f32 v71, v58, v59
    buffer_store_dwordx4 v[68:71], v23, s[56:59], s48 offen
L_pend_65:
concat_heads__sliding_block__softmax_full_mha__prompt_kernel_end:
    s_endpgm
L_wdma_68:
    s_and_b32 s48, s16, 3
    s_mul_i32 s48, s48, 5120
    s_cmp_eq_u32 s72, 1
    s_cselect_b32 s49, 0, 20480
    s_add_u32 s48, s48, s49
    buffer_load_dwordx4 v6, s[12:15], s34 offen sc1 lds
    s_add_u32 m0, m0, 8192
    s_add_u32 s34, s34, 8192
    v_and_b32 v2, 15, v1
    v_mul_u32_u24 v5, 320, v2
    v_add_u32 v5, s48, v5
    v_bfe_u32 v2, v1, 1, 2
    v_lshrrev_b32 v4, 4, v1
    v_mul_u32_u24 v4, 5, v4
    buffer_load_dwordx4 v6, s[12:15], s34 offen sc1 lds
    s_add_u32 m0, m0, 8192
    s_add_u32 s34, s34, 8192
    v_add_u32 v8, 0, v4
    v_xor_b32 v8, v8, v2
    v_lshl_add_u32 v8, v8, 4, v5
    v_add_u32 v9, 1, v4
    v_xor_b32 v9, v9, v2
    v_lshl_add_u32 v9, v9, 4, v5
    buffer_load_dwordx4 v6, s[12:15], s34 offen sc1 lds
    s_add_u32 m0, m0, 8192
    s_add_u32 s34, s34, 8192
    v_add_u32 v10, 2, v4
    v_xor_b32 v10, v10, v2
    v_lshl_add_u32 v10, v10, 4, v5
    v_add_u32 v12, 3, v4
    v_xor_b32 v12, v12, v2
    v_lshl_add_u32 v12, v12, 4, v5
    buffer_load_dwordx4 v6, s[12:15], s34 offen sc1 lds
    s_add_u32 m0, m0, 8192
    s_add_u32 s34, s34, 8192
    v_add_u32 v13, 4, v4
    v_xor_b32 v13, v13, v2
    v_lshl_add_u32 v13, v13, 4, v5
    s_mov_b32 s48, 429496730
    s_movk_i32 s49, 2400
    v_add_u32 v2, 0, v0
    buffer_load_dwordx4 v6, s[12:15], s34 offen sc1 lds
    s_add_u32 m0, m0, 8192
    s_add_u32 s34, s34, 8192
    v_mul_hi_u32 v4, s48, v2
    v_lshlrev_b32 v22, 4, v2
    v_mad_u32_u24 v22, v4, s49, v22
    v_mul_u32_u24 v5, 10, v4
    v_sub_u32 v2, v2, v5
    v_lshlrev_b32 v2, 1, v2
    buffer_load_dwordx4 v6, s[12:15], s34 offen sc1 lds
    s_add_u32 m0, m0, 8192
    s_add_u32 s34, s34, 8192
    v_bfe_u32 v5, v4, 1, 2
    v_xor_b32 v2, v2, v5
    v_mul_u32_u24 v4, 320, v4
    v_lshl_add_u32 v14, v2, 4, v4
    v_xor_b32 v15, 16, v14
    v_add_u32 v2, 512, v0
    buffer_load_dwordx4 v6, s[12:15], s34 offen sc1 lds
    s_add_u32 m0, m0, 8192
    s_add_u32 s34, s34, 8192
    v_mul_hi_u32 v4, s48, v2
    v_lshlrev_b32 v23, 4, v2
    v_mad_u32_u24 v23, v4, s49, v23
    v_mul_u32_u24 v5, 10, v4
    v_sub_u32 v2, v2, v5
    v_lshlrev_b32 v2, 1, v2
    buffer_load_dwordx4 v6, s[12:15], s34 offen sc1 lds
    s_add_u32 m0, m0, 8192
    s_add_u32 s34, s34, 8192
    v_bfe_u32 v5, v4, 1, 2
    v_xor_b32 v2, v2, v5
    v_mul_u32_u24 v4, 320, v4
    v_lshl_add_u32 v16, v2, 4, v4
    v_xor_b32 v18, 16, v16
    s_cmp_ge_u32 s16, 6
    s_cselect_b32 m0, 163840, m0
    s_nop 0
    buffer_load_dwordx4 v6, s[12:15], s34 offen sc1 lds
    s_add_u32 m0, m0, 8192
    s_add_u32 s34, s34, 8192
    s_cmp_eq_u32 s72, 0
    s_cbranch_scc1 L_wb0_69
    s_branch L_wb1_70
L_lateA_64:
    s_cmp_eq_u32 s16, 0
    s_cbranch_scc1 L_lateO_62
L_lw_86:
    ds_read_b32 v5, v4
    s_waitcnt lgkmcnt(0)
    v_readfirstlane_b32 s47, v5
    s_cmp_eq_u32 s47, 1
    s_cbranch_scc1 L_lo2_85
    s_add_u32 s92, s92, 1
    s_cmp_gt_u32 s92, 16000000
    s_cbranch_scc1 L_lo2_85
    s_sleep 1
    s_branch L_lw_86
L_lateO_62:
    buffer_load_dword v17, v28, s[12:15], s41 offen sc1
    s_waitcnt vmcnt(0)
    v_readfirstlane_b32 s47, v17
    s_cmp_eq_u32 s47, 32
    s_cbranch_scc1 L_lo2_85
    s_add_u32 s92, s92, 1
    s_cmp_gt_u32 s92, 2000000
    s_cbranch_scc1 L_lo2_85
    s_sleep 4
    s_branch L_lateO_62
L_lo2_85:
    s_cbranch_vccnz L_lo2_85_n
    ds_write_b32 v4, v3
L_lo2_85_n:
    s_xor_b32 s46, s42, 1
    s_mul_i32 s46, s46, 2621440
    s_lshl_b32 s44, s72, 13
    s_add_u32 s44, s44, s98
    s_add_u32 s44, s44, s46
    s_add_u32 s48, s44, 4096
    s_lshl_b32 s45, s72, 11
    s_add_u32 s45, s45, s98
    s_add_u32 s45, s45, s46
    s_add_u32 s45, s45, 16384
    buffer_load_dwordx4 v[188:191], v6, s[12:15], s44 offen offset:3072 sc1
    buffer_load_dwordx4 v[192:195], v6, s[12:15], s48 offen offset:0 sc1
    buffer_load_dwordx4 v[196:199], v6, s[12:15], s48 offen offset:1024 sc1
    buffer_load_dwordx4 v[200:203], v6, s[12:15], s48 offen offset:2048 sc1
    buffer_load_dwordx4 v[204:207], v6, s[12:15], s48 offen offset:3072 sc1
    buffer_load_dwordx2 v[208:209], v30, s[12:15], s45 offen offset:0 sc1
    buffer_load_dwordx2 v[210:211], v30, s[12:15], s45 offen offset:128 sc1
    buffer_load_dwordx2 v[212:213], v30, s[12:15], s45 offen offset:1024 sc1
    buffer_load_dwordx2 v[214:215], v30, s[12:15], s45 offen offset:1152 sc1
    buffer_load_dwordx4 v[176:179], v6, s[12:15], s44 offen offset:0 sc1
    buffer_load_dwordx4 v[180:183], v6, s[12:15], s44 offen offset:1024 sc1
    buffer_load_dwordx4 v[184:187], v6, s[12:15], s44 offen offset:2048 sc1
    s_cbranch_vccz L_backO_63
    s_waitcnt vmcnt(0)
    s_branch L_backO_63
concat_heads__sliding_block__softmax_full_mha__prompt_kernel_idle0:
    s_waitcnt lgkmcnt(0)
    s_cmp_lg_u32 s2, 255
    s_cbranch_scc1 L_nz_87
    s_cmp_lg_u32 s16, 0
    s_cbranch_scc1 L_nz_87_b
    s_mov_b32 s46, 20971520
    buffer_store_dword v28, v29, s[12:15], s46 offen sc1
    s_add_u32 s46, s46, 8192
    buffer_store_dword v28, v29, s[12:15], s46 offen sc1
    s_add_u32 s46, s46, 8192
    buffer_store_dword v28, v29, s[12:15], s46 offen sc1
    s_add_u32 s46, s46, 8192
    buffer_store_dword v28, v29, s[12:15], s46 offen sc1
    s_add_u32 s46, s46, 8192
    v_mov_b32 v2, 1
    s_waitcnt vmcnt(0)
    s_mov_b64 exec, 1
    buffer_store_dword v2, v28, s[60:63], 0 offen sc1
    s_mov_b64 exec, -1
L_nz_87_b:
    s_barrier
L_nz_87:
    s_mov_b32 s39, 0x20000
    s_lshl_b32 s48, s2, 2
    s_and_b32 s49, s16, 3
    s_add_u32 s49, s49, s48
    s_mul_i32 s48, s49, 2560
    s_mul_i32 s49, s49, 2432
    s_mov_b64 exec, 0xfffff
    buffer_load_dword v15, v29, s[28:31], s48 offen
    s_mov_b64 exec, 0x7ffff
    buffer_load_dword v16, v29, s[56:59], s49 offen
    s_mov_b64 exec, -1
    s_sub_u32 s46, s2, 240
    s_and_b32 s47, s46, 7
    s_cmp_ge_u32 s46, 8
    s_cselect_b64 s[36:37], s[64:65], s[66:67]
    s_mov_b32 s38, 819200
    s_mov_b32 s48, 429496730
    s_lshl_b32 s49, s16, 6
    s_mul_i32 s50, s47, 160
    s_movk_i32 s51, 1120
    v_add_u32 v4, s49, v1
    v_add_u32 v4, 0, v4
    v_mul_hi_u32 v2, s48, v4
    v_lshlrev_b32 v4, 4, v4
    v_mad_u32_u24 v4, v2, s51, v4
    v_add_u32 v176, s50, v4
    v_add_u32 v4, s49, v1
    v_add_u32 v4, 512, v4
    v_mul_hi_u32 v2, s48, v4
    v_lshlrev_b32 v4, 4, v4
    v_mad_u32_u24 v4, v2, s51, v4
    v_add_u32 v177, s50, v4
    v_add_u32 v4, s49, v1
    v_add_u32 v4, 1024, v4
    v_mul_hi_u32 v2, s48, v4
    v_lshlrev_b32 v4, 4, v4
    v_mad_u32_u24 v4, v2, s51, v4
    v_add_u32 v178, s50, v4
    v_add_u32 v4, s49, v1
    v_add_u32 v4, 1536, v4
    v_mul_hi_u32 v2, s48, v4
    v_lshlrev_b32 v4, 4, v4
    v_mad_u32_u24 v4, v2, s51, v4
    v_add_u32 v179, s50, v4
    v_add_u32 v4, s49, v1
    v_add_u32 v4, 2048, v4
    v_mul_hi_u32 v2, s48, v4
    v_lshlrev_b32 v4, 4, v4
    v_mad_u32_u24 v4, v2, s51, v4
    v_add_u32 v180, s50, v4
    s_lshl_b32 m0, s16, 10
    s_mov_b32 s49, 0
    buffer_load_dwordx4 v176, s[36:39], s49 offen lds
    s_add_u32 m0, m0, 8192
    s_nop 0
    buffer_load_dwordx4 v177, s[36:39], s49 offen lds
    s_add_u32 m0, m0, 8192
    s_nop 0
    buffer_load_dwordx4 v178, s[36:39], s49 offen lds
    s_add_u32 m0, m0, 8192
    s_nop 0
    buffer_load_dwordx4 v179, s[36:39], s49 offen lds
    s_add_u32 m0, m0, 8192
    s_nop 0
    buffer_load_dwordx4 v180, s[36:39], s49 offen lds
    s_add_u32 m0, m0, 8192
    s_add_u32 s49, s49, 327680
    buffer_load_dwordx4 v176, s[36:39], s49 offen lds
    s_add_u32 m0, m0, 8192
    s_nop 0
    buffer_load_dwordx4 v177, s[36:39], s49 offen lds
    s_add_u32 m0, m0, 8192
    s_nop 0
    buffer_load_dwordx4 v178, s[36:39], s49 offen lds
    s_add_u32 m0, m0, 8192
    s_nop 0
    buffer_load_dwordx4 v179, s[36:39], s49 offen lds
    s_add_u32 m0, m0, 8192
    s_nop 0
    buffer_load_dwordx4 v180, s[36:39], s49 offen lds
    s_add_u32 m0, m0, 8192
    s_add_u32 s49, s49, 327680
    buffer_load_dwordx4 v176, s[36:39], s49 offen lds
    s_add_u32 m0, m0, 8192
    s_nop 0
    buffer_load_dwordx4 v177, s[36:39], s49 offen lds
    s_add_u32 m0, m0, 8192
    s_nop 0
    buffer_load_dwordx4 v178, s[36:39], s49 offen lds
    s_add_u32 m0, m0, 8192
    s_nop 0
    s_mul_i32 s48, s16, 12800
    v_lshrrev_b32 v3, 5, v1
    v_mul_u32_u24 v4, 20, v3
    v_bfe_u32 v2, v1, 2, 3
    v_add_u32 v4, v4, v2
    v_mul_u32_u24 v4, 160, v4
    v_and_b32 v2, 3, v1
    v_mul_u32_u24 v2, 40, v2
    v_add3_u32 v182, v4, v2, s48
    s_mul_i32 s48, s16, 25600
    v_lshrrev_b32 v4, 4, v1
    v_mul_u32_u24 v4, 20, v4
    v_bfe_u32 v3, v1, 2, 2
    v_add3_u32 v4, v4, v3, 16
    v_mul_u32_u24 v4, 160, v4
    v_add3_u32 v183, v4, v2, s48
    s_mul_i32 s49, s46, 102400
    s_add_u32 s49, s49, 21004288
    s_lshr_b32 s52, s16, 2
    s_mul_i32 s53, s52, 15360
    s_mul_i32 s52, s52, 35840
    s_add_u32 s52, s52, 15360
    s_and_b32 s54, s16, 3
    s_mul_i32 s55, s54, 10240
    s_add_u32 s55, s55, s49
    s_cmp_lt_u32 s54, 2
    s_cselect_b32 s50, s53, s52
    s_add_u32 s50, s50, s55
    s_cmp_lt_u32 s54, 1
    s_cselect_b32 s45, s53, s52
    s_add_u32 s45, s45, s55
    s_add_u32 s45, s45, 5120
    s_lshr_b32 s51, s16, 1
    s_mul_i32 s51, s51, 35840
    s_and_b32 s52, s16, 1
    s_mul_i32 s52, s52, 5120
    s_add_u32 s51, s51, s52
    s_add_u32 s51, s51, 56320
    s_add_u32 s51, s51, s49
    s_cmp_lt_u32 s16, 4
    s_cselect_b32 s51, s51, 1073741824
    s_waitcnt vmcnt(0)
    s_barrier
    ds_read_b64_tr_b16 v[112:113], v182 offset:0
    ds_read_b64_tr_b16 v[114:115], v182 offset:1280
    ds_read_b64_tr_b16 v[116:117], v182 offset:8
    ds_read_b64_tr_b16 v[118:119], v182 offset:1288
    ds_read_b64_tr_b16 v[120:121], v182 offset:16
    ds_read_b64_tr_b16 v[122:123], v182 offset:1296
    ds_read_b64_tr_b16 v[124:125], v182 offset:24
    ds_read_b64_tr_b16 v[126:127], v182 offset:1304
    ds_read_b64_tr_b16 v[128:129], v182 offset:32
    ds_read_b64_tr_b16 v[130:131], v182 offset:1312
    s_waitcnt lgkmcnt(0)
    buffer_store_dwordx4 v[112:115], v6, s[12:15], s50 offen offset:0 sc1
    buffer_store_dwordx4 v[116:119], v6, s[12:15], s50 offen offset:1024 sc1
    buffer_store_dwordx4 v[120:123], v6, s[12:15], s50 offen offset:2048 sc1
    buffer_store_dwordx4 v[124:127], v6, s[12:15], s50 offen offset:3072 sc1
    s_add_u32 s50, s50, 4096
    buffer_store_dwordx4 v[128:131], v6, s[12:15], s50 offen offset:0 sc1
    ds_read_b64_tr_b16 v[132:133], v182 offset:6400
    ds_read_b64_tr_b16 v[134:135], v182 offset:7680
    ds_read_b64_tr_b16 v[136:137], v182 offset:6408
    ds_read_b64_tr_b16 v[138:139], v182 offset:7688
    ds_read_b64_tr_b16 v[140:141], v182 offset:6416
    ds_read_b64_tr_b16 v[142:143], v182 offset:7696
    ds_read_b64_tr_b16 v[144:145], v182 offset:6424
    ds_read_b64_tr_b16 v[146:147], v182 offset:7704
    ds_read_b64_tr_b16 v[148:149], v182 offset:6432
    ds_read_b64_tr_b16 v[150:151], v182 offset:7712
    s_waitcnt lgkmcnt(0)
    buffer_store_dwordx4 v[132:135], v6, s[12:15], s45 offen offset:0 sc1
    buffer_store_dwordx4 v[136:139], v6, s[12:15], s45 offen offset:1024 sc1
    buffer_store_dwordx4 v[140:143], v6, s[12:15], s45 offen offset:2048 sc1
    buffer_store_dwordx4 v[144:147], v6, s[12:15], s45 offen offset:3072 sc1
    s_add_u32 s45, s45, 4096
    buffer_store_dwordx4 v[148:151], v6, s[12:15], s45 offen offset:0 sc1
    ds_read_b64_tr_b16 v[152:153], v183 offset:0
    ds_read_b64_tr_b16 v[154:155], v183 offset:12800
    ds_read_b64_tr_b16 v[156:157], v183 offset:8
    ds_read_b64_tr_b16 v[158:159], v183 offset:12808
    ds_read_b64_tr_b16 v[160:161], v183 offset:16
    ds_read_b64_tr_b16 v[162:163], v183 offset:12816
    ds_read_b64_tr_b16 v[164:165], v183 offset:24
    ds_read_b64_tr_b16 v[166:167], v183 offset:12824
    ds_read_b64_tr_b16 v[168:169], v183 offset:32
    ds_read_b64_tr_b16 v[170:171], v183 offset:12832
    s_waitcnt lgkmcnt(0)
    buffer_store_dwordx4 v[152:155], v6, s[12:15], s51 offen offset:0 sc1
    buffer_store_dwordx4 v[156:159], v6, s[12:15], s51 offen offset:1024 sc1
    buffer_store_dwordx4 v[160:163], v6, s[12:15], s51 offen offset:2048 sc1
    buffer_store_dwordx4 v[164:167], v6, s[12:15], s51 offen offset:3072 sc1
    s_add_u32 s51, s51, 4096
    buffer_store_dwordx4 v[168:171], v6, s[12:15], s51 offen offset:0 sc1
    s_waitcnt vmcnt(0)
    s_barrier
    s_cmp_lg_u32 s16, 0
    s_cbranch_scc1 concat_heads__sliding_block__softmax_full_mha__prompt_kernel_main
L_zz_90:
    buffer_load_dword v17, v28, s[60:63], 0 offen sc1
    s_waitcnt vmcnt(0)
    v_readfirstlane_b32 s48, v17
    s_cmp_eq_u32 s48, 1
    s_cbranch_scc1 L_zo_91
    s_add_u32 s92, s92, 1
    s_cmp_gt_u32 s92, 2000000
    s_cbranch_scc1 L_zo_91
    s_sleep 8
    s_branch L_zz_90
L_zo_91:
    s_lshl_b32 s47, s47, 7
    s_add_u32 s47, s47, 20998144
    v_mov_b32 v2, 1
    s_mov_b64 exec, 1
    buffer_atomic_add v2, v28, s[12:15], s47 offen sc1
    s_mov_b64 exec, -1
    s_branch concat_heads__sliding_block__softmax_full_mha__prompt_kernel_main
concat_heads__sliding_block__softmax_full_mha__prompt_kernel_idle:
    s_mov_b32 s45, 0
L_z2_88:
    buffer_load_dword v17, v28, s[60:63], 0 offen offset:128 sc1
    s_waitcnt vmcnt(0)
    v_readfirstlane_b32 s46, v17
    s_cmp_eq_u32 s46, 1
    s_cbranch_scc1 L_z3_92
    s_add_u32 s92, s92, 1
    s_cmp_gt_u32 s92, 2000000
    s_cbranch_scc1 L_z3_92
    s_sleep 8
    s_branch L_z2_88
L_z3_92:
    buffer_load_dword v17, v18, s[12:15], s54 offen sc1
    s_waitcnt vmcnt(0)
    v_cmp_ne_u32 vcc, s55, v17
    s_cbranch_vccz L_go_12
    s_add_u32 s92, s92, 1
    s_cmp_gt_u32 s92, 2000000
    s_cbranch_scc1 L_go_12
    s_sleep 8
    v_readfirstlane_b32 s46, v17
    s_cmp_lg_u32 s46, 0
    s_cbranch_scc1 L_z3_92
    s_sleep 8
    s_branch L_z3_92
L_waitA_31:
    s_add_u32 s92, s92, 1
    s_cmp_gt_u32 s92, 2000000
    s_cbranch_scc1 L_okA_32
    s_sleep 2
    buffer_load_dword v17, v22, s[12:15], s97 offen sc1
    s_waitcnt vmcnt(0)
    v_cmp_ne_u32 vcc, v23, v17
    s_cbranch_vccnz L_waitA_31
    s_branch L_okA_32
L_t0_33:
    ds_read2st64_b64 v[160:163], v11 offset0:45 offset1:46
    s_mov_b64 exec, s[26:27]
    ds_read_b64 v[40:41], v11 offset:24064
    s_mov_b64 exec, -1
    s_waitcnt lgkmcnt(0)
    v_mfma_f32_32x32x8_bf16 v[128:143], v[40:41], v[36:37], 0
    v_mfma_f32_32x32x16_bf16 v[128:143], v[160:163], v[152:155], v[128:143]
    s_nop 10
    s_mov_b32 exec_lo, 0x0
    s_mov_b32 exec_hi, 0xf
    v_mov_b32 v128, s19
    s_mov_b32 exec_lo, 0x1
    s_mov_b32 exec_hi, 0x1f
    v_mov_b32 v129, s19
    s_mov_b32 exec_lo, 0x3
    s_mov_b32 exec_hi, 0x3f
    v_mov_b32 v130, s19
    s_mov_b32 exec_lo, 0x7
    s_mov_b32 exec_hi, 0x7f
    v_mov_b32 v131, s19
    s_mov_b32 exec_lo, 0xff
    s_mov_b32 exec_hi, 0xfff
    v_mov_b32 v132, s19
    s_mov_b32 exec_lo, 0x1ff
    s_mov_b32 exec_hi, 0x1fff
    v_mov_b32 v133, s19
    s_mov_b32 exec_lo, 0x3ff
    s_mov_b32 exec_hi, 0x3fff
    v_mov_b32 v134, s19
    s_mov_b32 exec_lo, 0x7ff
    s_mov_b32 exec_hi, 0x7fff
    v_mov_b32 v135, s19
    s_mov_b32 exec_lo, 0xffff
    s_mov_b32 exec_hi, 0xfffff
    v_mov_b32 v136, s19
    s_mov_b32 exec_lo, 0x1ffff
    s_mov_b32 exec_hi, 0x1fffff
    v_mov_b32 v137, s19
    s_mov_b32 exec_lo, 0x3ffff
    s_mov_b32 exec_hi, 0x3fffff
    v_mov_b32 v138, s19
    s_mov_b32 exec_lo, 0x7ffff
    s_mov_b32 exec_hi, 0x7fffff
    v_mov_b32 v139, s19
    s_mov_b32 exec_lo, 0xffffff
    s_mov_b32 exec_hi, 0xfffffff
    v_mov_b32 v140, s19
    s_mov_b32 exec_lo, 0x1ffffff
    s_mov_b32 exec_hi, 0x1fffffff
    v_mov_b32 v141, s19
    s_mov_b32 exec_lo, 0x3ffffff
    s_mov_b32 exec_hi, 0x3fffffff
    v_mov_b32 v142, s19
    s_mov_b32 exec_lo, 0x7ffffff
    s_mov_b32 exec_hi, 0x7fffffff
    v_mov_b32 v143, s19
    s_mov_b64 exec, -1
    s_branch L_t0b_34
L_ma_45:
    s_waitcnt lgkmcnt(0)
    v_mfma_f32_32x32x16_bf16 v[216:231], v[44:47], v[164:167], v[216:231]
    v_mfma_f32_32x32x16_bf16 v[216:231], v[48:51], v[168:171], v[216:231]
    s_branch L_at_44
L_ma_46:
    s_waitcnt lgkmcnt(0)
    v_mfma_f32_32x32x16_bf16 v[216:231], v[52:55], v[60:63], v[216:231]
    v_mfma_f32_32x32x16_bf16 v[216:231], v[56:59], v[64:67], v[216:231]
    s_branch L_at_44
L_ma_47:
    s_waitcnt lgkmcnt(0)
    v_mfma_f32_32x32x16_bf16 v[216:231], v[44:47], v[164:167], v[216:231]
    v_mfma_f32_32x32x16_bf16 v[216:231], v[48:51], v[168:171], v[216:231]
    s_branch L_at_44
L_ma_48:
    s_waitcnt lgkmcnt(0)
    v_mfma_f32_32x32x16_bf16 v[216:231], v[52:55], v[60:63], v[216:231]
    v_mfma_f32_32x32x16_bf16 v[216:231], v[56:59], v[64:67], v[216:231]
    s_branch L_at_44
L_ma_49:
    s_waitcnt lgkmcnt(0)
    v_mfma_f32_32x32x16_bf16 v[216:231], v[44:47], v[164:167], v[216:231]
    v_mfma_f32_32x32x16_bf16 v[216:231], v[48:51], v[168:171], v[216:231]
    s_branch L_at_44
L_ma_50:
    s_waitcnt lgkmcnt(0)
    v_mfma_f32_32x32x16_bf16 v[216:231], v[52:55], v[60:63], v[216:231]
    v_mfma_f32_32x32x16_bf16 v[216:231], v[56:59], v[64:67], v[216:231]
    s_branch L_at_44
L_ma_51:
    s_waitcnt lgkmcnt(0)
    v_mfma_f32_32x32x16_bf16 v[216:231], v[44:47], v[164:167], v[216:231]
    v_mfma_f32_32x32x16_bf16 v[216:231], v[48:51], v[168:171], v[216:231]
    s_branch L_at_44
L_ma_52:
    s_waitcnt lgkmcnt(0)
    v_mfma_f32_32x32x16_bf16 v[216:231], v[52:55], v[60:63], v[216:231]
    v_mfma_f32_32x32x16_bf16 v[216:231], v[56:59], v[64:67], v[216:231]
    s_branch L_at_44
L_slow_53:
    s_mov_b64 exec, s[100:101]
    v_mov_b32 v36, 0
    v_mov_b32 v37, 0
    s_mov_b64 exec, -1
    s_sub_u32 s36, s74, 8
    s_max_i32 s36, s36, 0
    s_mov_b32 s37, s74
    s_movk_i32 s38, 256
    s_lshl_b32 s39, s74, 5
    s_sub_u32 s39, s39, 255
    v_and_b32 v16, 31, v1
    v_add_u32 v16, s39, v16
    v_lshrrev_b32 v3, 5, v1
    v_lshlrev_b32 v4, 2, v3
    v_sub_u32 v16, v16, v4
    v_mov_b32 v15, s19
    v_mov_b32 v128, s19
    s_add_u32 s40, s70, 0
    s_lshl_b32 s40, s40, 6
    s_mov_b32 s41, 0
    v_mov_b32 v216, 0
    v_mov_b32 v217, 0
    v_mov_b32 v218, 0
    v_mov_b32 v219, 0
    v_mov_b32 v220, 0
    v_mov_b32 v221, 0
    v_mov_b32 v222, 0
    v_mov_b32 v223, 0
    v_mov_b32 v224, 0
    v_mov_b32 v225, 0
    v_mov_b32 v226, 0
    v_mov_b32 v227, 0
    v_mov_b32 v228, 0
    v_mov_b32 v229, 0
    v_mov_b32 v230, 0
    v_mov_b32 v231, 0
L_pass_94:
    s_mov_b32 s54, s36
L_tile_95:
    s_add_u32 s55, s40, s54
    s_mul_i32 s55, s55, 2560
    buffer_load_dwordx2 v[156:157], v8, s[12:15], s55 offen sc1
    buffer_load_dwordx2 v[158:159], v8, s[12:15], s55 offen offset:512 sc1
    buffer_load_dwordx2 v[38:39], v9, s[12:15], s55 offen sc1
    s_mov_b64 exec, s[24:25]
    buffer_load_dwordx4 v[44:47], v10, s[12:15], s55 offen sc1
    buffer_load_dwordx4 v[48:51], v10, s[12:15], s55 offen offset:640 sc1
    s_mov_b64 exec, -1
    s_lshl_b32 s39, s54, 5
    v_sub_u32 v2, s39, v16
    s_waitcnt vmcnt(0)
    v_mfma_f32_32x32x8_bf16 v[112:127], v[38:39], v[36:37], 0
    v_mfma_f32_32x32x16_bf16 v[112:127], v[156:159], v[152:155], v[112:127]
    s_nop 15
    v_add_u32 v3, 0, v2
    v_cmp_gt_u32 vcc, s38, v3
    s_nop 1
    v_cndmask_b32 v112, v128, v112, vcc
    v_add_u32 v3, 1, v2
    v_cmp_gt_u32 vcc, s38, v3
    s_nop 1
    v_cndmask_b32 v113, v128, v113, vcc
    v_add_u32 v3, 2, v2
    v_cmp_gt_u32 vcc, s38, v3
    s_nop 1
    v_cndmask_b32 v114, v128, v114, vcc
    v_add_u32 v3, 3, v2
    v_cmp_gt_u32 vcc, s38, v3
    s_nop 1
    v_cndmask_b32 v115, v128, v115, vcc
    v_add_u32 v3, 8, v2
    v_cmp_gt_u32 vcc, s38, v3
    s_nop 1
    v_cndmask_b32 v116, v128, v116, vcc
    v_add_u32 v3, 9, v2
    v_cmp_gt_u32 vcc, s38, v3
    s_nop 1
    v_cndmask_b32 v117, v128, v117, vcc
    v_add_u32 v3, 10, v2
    v_cmp_gt_u32 vcc, s38, v3
    s_nop 1
    v_cndmask_b32 v118, v128, v118, vcc
    v_add_u32 v3, 11, v2
    v_cmp_gt_u32 vcc, s38, v3
    s_nop 1
    v_cndmask_b32 v119, v128, v119, vcc
    v_add_u32 v3, 16, v2
    v_cmp_gt_u32 vcc, s38, v3
    s_nop 1
    v_cndmask_b32 v120, v128, v120, vcc
    v_add_u32 v3, 17, v2
    v_cmp_gt_u32 vcc, s38, v3
    s_nop 1
    v_cndmask_b32 v121, v128, v121, vcc
    v_add_u32 v3, 18, v2
    v_cmp_gt_u32 vcc, s38, v3
    s_nop 1
    v_cndmask_b32 v122, v128, v122, vcc
    v_add_u32 v3, 19, v2
    v_cmp_gt_u32 vcc, s38, v3
    s_nop 1
    v_cndmask_b32 v123, v128, v123, vcc
    v_add_u32 v3, 24, v2
    v_cmp_gt_u32 vcc, s38, v3
    s_nop 1
    v_cndmask_b32 v124, v128, v124, vcc
    v_add_u32 v3, 25, v2
    v_cmp_gt_u32 vcc, s38, v3
    s_nop 1
    v_cndmask_b32 v125, v128, v125, vcc
    v_add_u32 v3, 26, v2
    v_cmp_gt_u32 vcc, s38, v3
    s_nop 1
    v_cndmask_b32 v126, v128, v126, vcc
    v_add_u32 v3, 27, v2
    v_cmp_gt_u32 vcc, s38, v3
    s_nop 1
    v_cndmask_b32 v127, v128, v127, vcc
    s_cmp_eq_u32 s41, 1
    s_cbranch_scc1 L_p2_96
    v_max3_f32 v15, v15, v112, v113
    v_max3_f32 v15, v15, v114, v115
    v_max3_f32 v15, v15, v116, v117
    v_max3_f32 v15, v15, v118, v119
    v_max3_f32 v15, v15, v120, v121
    v_max3_f32 v15, v15, v122, v123
    v_max3_f32 v15, v15, v124, v125
    v_max3_f32 v15, v15, v126, v127
    s_branch L_nx_97
L_p2_96:
    v_sub_f32 v112, v112, v15
    v_sub_f32 v113, v113, v15
    v_sub_f32 v114, v114, v15
    v_sub_f32 v115, v115, v15
    v_sub_f32 v116, v116, v15
    v_sub_f32 v117, v117, v15
    v_sub_f32 v118, v118, v15
    v_sub_f32 v119, v119, v15
    v_sub_f32 v120, v120, v15
    v_sub_f32 v121, v121, v15
    v_sub_f32 v122, v122, v15
    v_sub_f32 v123, v123, v15
    v_sub_f32 v124, v124, v15
    v_sub_f32 v125, v125, v15
    v_sub_f32 v126, v126, v15
    v_sub_f32 v127, v127, v15
    v_exp_f32 v112, v112
    v_exp_f32 v113, v113
    v_exp_f32 v114, v114
    v_exp_f32 v115, v115
    v_cvt_pk_bf16_f32 v164, v112, v113
    v_cvt_pk_bf16_f32 v165, v114, v115
    v_exp_f32 v116, v116
    v_exp_f32 v117, v117
    v_exp_f32 v118, v118
    v_exp_f32 v119, v119
    v_cvt_pk_bf16_f32 v166, v116, v117
    v_cvt_pk_bf16_f32 v167, v118, v119
    v_exp_f32 v120, v120
    v_exp_f32 v121, v121
    v_exp_f32 v122, v122
    v_exp_f32 v123, v123
    v_cvt_pk_bf16_f32 v168, v120, v121
    v_cvt_pk_bf16_f32 v169, v122, v123
    v_exp_f32 v124, v124
    v_exp_f32 v125, v125
    v_exp_f32 v126, v126
    v_exp_f32 v127, v127
    v_cvt_pk_bf16_f32 v170, v124, v125
    v_cvt_pk_bf16_f32 v171, v126, v127
    s_nop 1
    v_mfma_f32_32x32x16_bf16 v[216:231], v[44:47], v[164:167], v[216:231]
    v_mfma_f32_32x32x16_bf16 v[216:231], v[48:51], v[168:171], v[216:231]
    s_nop 7
L_nx_97:
    s_add_u32 s54, s54, 1
    s_cmp_le_u32 s54, s37
    s_cbranch_scc1 L_tile_95
    s_nop 15
    s_cmp_eq_u32 s41, 1
    s_cbranch_scc1 L_dn_93
    v_mov_b32 v5, v15
    s_nop 1
    v_permlane32_swap_b32 v5, v15
    s_nop 1
    v_max_f32 v15, v15, v5
    s_mov_b32 s41, 1
    s_branch L_pass_94
L_dn_93:
    v_mov_b32 v38, 1065369472
    v_mov_b32 v39, 1065369472
    s_branch L_ret_54
L_slow_66:
    s_mov_b64 exec, s[100:101]
    v_mov_b32 v32, 0
    v_mov_b32 v33, 0
    s_mov_b64 exec, -1
    s_mov_b32 s36, 0
    s_mov_b32 s37, 63
    s_movk_i32 s38, 2048
    v_mov_b32 v16, 0
    v_lshrrev_b32 v3, 5, v1
    v_lshlrev_b32 v4, 2, v3
    v_sub_u32 v16, v16, v4
    v_mov_b32 v15, s19
    v_mov_b32 v128, s19
    s_add_u32 s40, s70, 32
    s_lshl_b32 s40, s40, 6
    s_mov_b32 s41, 0
    v_mov_b32 v68, 0
    v_mov_b32 v69, 0
    v_mov_b32 v70, 0
    v_mov_b32 v71, 0
    v_mov_b32 v72, 0
    v_mov_b32 v73, 0
    v_mov_b32 v74, 0
    v_mov_b32 v75, 0
    v_mov_b32 v76, 0
    v_mov_b32 v77, 0
    v_mov_b32 v78, 0
    v_mov_b32 v79, 0
    v_mov_b32 v80, 0
    v_mov_b32 v81, 0
    v_mov_b32 v82, 0
    v_mov_b32 v83, 0
L_pass_99:
    s_mov_b32 s54, s36
L_tile_100:
    s_add_u32 s55, s40, s54
    s_mul_i32 s55, s55, 2560
    buffer_load_dwordx2 v[156:157], v8, s[12:15], s55 offen sc1
    buffer_load_dwordx2 v[158:159], v8, s[12:15], s55 offen offset:512 sc1
    buffer_load_dwordx2 v[38:39], v9, s[12:15], s55 offen sc1
    s_mov_b64 exec, s[24:25]
    buffer_load_dwordx4 v[44:47], v10, s[12:15], s55 offen sc1
    buffer_load_dwordx4 v[48:51], v10, s[12:15], s55 offen offset:640 sc1
    s_mov_b64 exec, -1
    s_lshl_b32 s39, s54, 5
    v_sub_u32 v2, s39, v16
    s_waitcnt vmcnt(0)
    v_mfma_f32_32x32x8_bf16 v[112:127], v[38:39], v[32:33], 0
    v_mfma_f32_32x32x16_bf16 v[112:127], v[156:159], v[144:147], v[112:127]
    s_nop 15
    v_add_u32 v3, 0, v2
    v_cmp_gt_u32 vcc, s38, v3
    s_nop 1
    v_cndmask_b32 v112, v128, v112, vcc
    v_add_u32 v3, 1, v2
    v_cmp_gt_u32 vcc, s38, v3
    s_nop 1
    v_cndmask_b32 v113, v128, v113, vcc
    v_add_u32 v3, 2, v2
    v_cmp_gt_u32 vcc, s38, v3
    s_nop 1
    v_cndmask_b32 v114, v128, v114, vcc
    v_add_u32 v3, 3, v2
    v_cmp_gt_u32 vcc, s38, v3
    s_nop 1
    v_cndmask_b32 v115, v128, v115, vcc
    v_add_u32 v3, 8, v2
    v_cmp_gt_u32 vcc, s38, v3
    s_nop 1
    v_cndmask_b32 v116, v128, v116, vcc
    v_add_u32 v3, 9, v2
    v_cmp_gt_u32 vcc, s38, v3
    s_nop 1
    v_cndmask_b32 v117, v128, v117, vcc
    v_add_u32 v3, 10, v2
    v_cmp_gt_u32 vcc, s38, v3
    s_nop 1
    v_cndmask_b32 v118, v128, v118, vcc
    v_add_u32 v3, 11, v2
    v_cmp_gt_u32 vcc, s38, v3
    s_nop 1
    v_cndmask_b32 v119, v128, v119, vcc
    v_add_u32 v3, 16, v2
    v_cmp_gt_u32 vcc, s38, v3
    s_nop 1
    v_cndmask_b32 v120, v128, v120, vcc
    v_add_u32 v3, 17, v2
    v_cmp_gt_u32 vcc, s38, v3
    s_nop 1
    v_cndmask_b32 v121, v128, v121, vcc
    v_add_u32 v3, 18, v2
    v_cmp_gt_u32 vcc, s38, v3
    s_nop 1
    v_cndmask_b32 v122, v128, v122, vcc
    v_add_u32 v3, 19, v2
    v_cmp_gt_u32 vcc, s38, v3
    s_nop 1
    v_cndmask_b32 v123, v128, v123, vcc
    v_add_u32 v3, 24, v2
    v_cmp_gt_u32 vcc, s38, v3
    s_nop 1
    v_cndmask_b32 v124, v128, v124, vcc
    v_add_u32 v3, 25, v2
    v_cmp_gt_u32 vcc, s38, v3
    s_nop 1
    v_cndmask_b32 v125, v128, v125, vcc
    v_add_u32 v3, 26, v2
    v_cmp_gt_u32 vcc, s38, v3
    s_nop 1
    v_cndmask_b32 v126, v128, v126, vcc
    v_add_u32 v3, 27, v2
    v_cmp_gt_u32 vcc, s38, v3
    s_nop 1
    v_cndmask_b32 v127, v128, v127, vcc
    s_cmp_eq_u32 s41, 1
    s_cbranch_scc1 L_p2_101
    v_max3_f32 v15, v15, v112, v113
    v_max3_f32 v15, v15, v114, v115
    v_max3_f32 v15, v15, v116, v117
    v_max3_f32 v15, v15, v118, v119
    v_max3_f32 v15, v15, v120, v121
    v_max3_f32 v15, v15, v122, v123
    v_max3_f32 v15, v15, v124, v125
    v_max3_f32 v15, v15, v126, v127
    s_branch L_nx_102
L_p2_101:
    v_sub_f32 v112, v112, v15
    v_sub_f32 v113, v113, v15
    v_sub_f32 v114, v114, v15
    v_sub_f32 v115, v115, v15
    v_sub_f32 v116, v116, v15
    v_sub_f32 v117, v117, v15
    v_sub_f32 v118, v118, v15
    v_sub_f32 v119, v119, v15
    v_sub_f32 v120, v120, v15
    v_sub_f32 v121, v121, v15
    v_sub_f32 v122, v122, v15
    v_sub_f32 v123, v123, v15
    v_sub_f32 v124, v124, v15
    v_sub_f32 v125, v125, v15
    v_sub_f32 v126, v126, v15
    v_sub_f32 v127, v127, v15
    v_exp_f32 v112, v112
    v_exp_f32 v113, v113
    v_exp_f32 v114, v114
    v_exp_f32 v115, v115
    v_cvt_pk_bf16_f32 v164, v112, v113
    v_cvt_pk_bf16_f32 v165, v114, v115
    v_exp_f32 v116, v116
    v_exp_f32 v117, v117
    v_exp_f32 v118, v118
    v_exp_f32 v119, v119
    v_cvt_pk_bf16_f32 v166, v116, v117
    v_cvt_pk_bf16_f32 v167, v118, v119
    v_exp_f32 v120, v120
    v_exp_f32 v121, v121
    v_exp_f32 v122, v122
    v_exp_f32 v123, v123
    v_cvt_pk_bf16_f32 v168, v120, v121
    v_cvt_pk_bf16_f32 v169, v122, v123
    v_exp_f32 v124, v124
    v_exp_f32 v125, v125
    v_exp_f32 v126, v126
    v_exp_f32 v127, v127
    v_cvt_pk_bf16_f32 v170, v124, v125
    v_cvt_pk_bf16_f32 v171, v126, v127
    s_nop 1
    v_mfma_f32_32x32x16_bf16 v[68:83], v[44:47], v[164:167], v[68:83]
    v_mfma_f32_32x32x16_bf16 v[68:83], v[48:51], v[168:171], v[68:83]
    s_nop 7
L_nx_102:
    s_add_u32 s54, s54, 1
    s_cmp_le_u32 s54, s37
    s_cbranch_scc1 L_tile_100
    s_nop 15
    s_cmp_eq_u32 s41, 1
    s_cbranch_scc1 L_dn_98
    v_mov_b32 v5, v15
    s_nop 1
    v_permlane32_swap_b32 v5, v15
    s_nop 1
    v_max_f32 v15, v15, v5
    s_mov_b32 s41, 1
    s_branch L_pass_99
L_dn_98:
    v_mov_b32 v38, 1065369472
    v_mov_b32 v39, 1065369472
    s_branch L_ret_67
concat_heads__sliding_block__softmax_full_mha__prompt_kernel_codeend:
    s_endpgm
.section .rodata,"a"
.p2align 6
.amdhsa_kernel concat_heads__sliding_block__softmax_full_mha__prompt_kernel
  .amdhsa_next_free_vgpr 252
  .amdhsa_next_free_sgpr 102
  .amdhsa_accum_offset 252
  .amdhsa_group_segment_fixed_size 0
  .amdhsa_kernarg_size 72
  .amdhsa_user_sgpr_count 2
  .amdhsa_user_sgpr_kernarg_segment_ptr 1
  .amdhsa_system_sgpr_workgroup_id_x 1
.end_amdhsa_kernel
```
